```python
import torch

def _softmax(x, axis=-1):
    return torch.softmax(x, dim=axis)
def _gelu(x):
    return torch.nn.functional.gelu(x, approximate="tanh")
def _silu(x):
    return torch.nn.functional.silu(x)
def _sigmoid(x):
    return torch.sigmoid(x)
def _layernorm(x, axis=-1, eps=1e-5):
    m = x.mean(dim=axis, keepdim=True)
    v = x.var(dim=axis, keepdim=True, unbiased=False)
    return (x - m) / torch.sqrt(v + eps)
def _scatter_add(tgt, idx, src, axis=0):
    return tgt.clone().index_add_(axis, idx, src)
def _segment_sum(src, seg, n):
    out = torch.zeros((n,) + src.shape[1:], dtype=src.dtype)
    return out.index_add_(0, seg, src)
def _pad(x, pw):
    flat = tuple(v for pair in reversed(pw) for v in pair)
    return torch.nn.functional.pad(x, flat)

kernel_name = 'standalone__sliding_local_dilated__prompt'

def setup_inputs():

    _w = (lambda a: (lambda t: t.to(torch.bfloat16) if t.is_floating_point() else t)(torch.as_tensor(a)))
    B, S, D = 1, 2048, 576
    return {
        "x": _w((lambda *s: torch.randn(*s, dtype=torch.bfloat16) * 0.2)(B, S, D)),
        "wqkv": _w((lambda *s: torch.randn(*s, dtype=torch.bfloat16) * 0.2)(D, 3 * D)),
        "wo": _w((lambda *s: torch.randn(*s, dtype=torch.bfloat16) * 0.05)(D, D)),
    }

def reference(x, wqkv, wo):
    B, S, D = x.shape
    H = 32; Dh = D // H
    W, dil = 8, 2
    qkv = (lambda x, *d: x.permute(*d))((x @ wqkv).reshape(B, S, 3, H, Dh), 2, 0, 3, 1, 4)
    q, k, v = qkv[0], qkv[1], qkv[2]
    scale = Dh ** -0.5
    pos = torch.arange(S)
    off = torch.arange(W) * dil
    idx = pos[:, None] - off[None, :]
    mask = idx >= 0
    idx_c = torch.where(mask, idx, 0).reshape(-1)
    kg = k[:, :, idx_c, :].reshape(B, H, S, W, Dh)
    vg = v[:, :, idx_c, :].reshape(B, H, S, W, Dh)
    logits = torch.einsum("bhsd,bhswd->bhsw", q, kg) * scale
    logits = torch.where(mask[None, None, :, :], logits, -1e9)
    attn = _softmax(logits, axis=-1)
    o = torch.einsum("bhsw,bhswd->bhsd", attn, vg)
    return (lambda x, *d: x.permute(*d))(o, 0, 2, 1, 3).reshape(B, S, D) @ wo
```

```asm
; @launch grid=(256,1,1) block=(256,1,1) lds=163840
.amdgcn_target "amdgcn-amd-amdhsa--gfx950"
.text
.globl standalone__sliding_local_dilated__prompt_kernel
.p2align 12
.p2align 8
.type standalone__sliding_local_dilated__prompt_kernel,@function
standalone__sliding_local_dilated__prompt_kernel:
    s_load_dwordx8 s[28:35], s[0:1], 0
    s_load_dwordx4 s[36:39], s[0:1], 32
    s_cmp_ge_u32 s2, 256
    s_cbranch_scc1 L_end
    s_lshr_b32 s52, s2, 3
    s_getpc_b64 s[56:57]
    v_lshrrev_b32 v120, 6, v0
    s_lshl_b32 s53, s52, 9
    v_lshl_add_u32 v123, v120, 7, s53
    v_min_u32 v123, L_code_end-standalone__sliding_local_dilated__prompt_kernel-64, v123
    global_load_dword v63, v123, s[56:57]
    s_and_b32 s51, s2, 7
    v_readfirstlane_b32 s40, v120
    s_lshr_b32 s47, 5408, s51
    s_and_b32 s47, s47, 32
    s_add_u32 s52, s52, s47
    s_lshr_b32 s83, s51, 1
    s_cmp_eq_u32 s52, 63
    s_cbranch_scc1 L_agent
    v_mov_b32 v136, 0
    v_mov_b32 v137, 0
    v_mov_b32 v138, 0
    v_mov_b32 v139, 0
    v_lshlrev_b32 v123, 4, v0
    v_add_u32 v123, 79872, v123
    ds_write_b128 v123, v[136:139] offset:0
    ds_write_b128 v123, v[136:139] offset:4096
    s_mul_i32 s42, s52, 37
    s_lshr_b32 s42, s42, 8
    s_mul_i32 s53, s42, 7
    s_sub_u32 s43, s52, s53
    s_and_b32 s53, s83, 1
    s_mul_i32 s53, s53, 7
    s_add_u32 s44, s43, s53
    s_mul_i32 s54, s44, 146
    s_lshr_b32 s53, s51, 2
    s_add_u32 s54, s54, s53
    s_mul_i32 s54, s54, 1152
    s_lshl_b32 s55, s42, 7
    ds_write_b128 v123, v[136:139] offset:8192
    ds_write_b128 v123, v[136:139] offset:12288
    s_add_u32 s53, s42, s43
    s_and_b32 s53, s53, 3
    s_mov_b32 s98, 0x10638880
    s_movk_i32 s99, 0x465
    s_cmp_eq_u32 s53, 1
    s_cmov_b32 s98, 0xc728c40
    s_cmovk_i32 s99, 0x504
    s_cmp_eq_u32 s53, 2
    s_cmov_b32 s98, 0x10311001
    s_cmovk_i32 s99, 0x18e5
    s_cmp_eq_u32 s53, 3
    s_cmov_b32 s98, 0x2441460
    s_cmovk_i32 s99, 0x18e2
    s_lshl_b32 s53, s51, 2
    s_lshr_b32 s53, 0x36151414, s53
    s_and_b32 s53, s53, 15
    s_mul_i32 s53, s53, 0x2108421
    s_add_u32 s98, s98, s53
    s_add_u32 s99, s99, s53
    s_add_u32 s56, s98, 0xe739ce7
    s_lshr_b32 s56, s56, 4
    s_and_b32 s56, s56, 0x2108421
    s_mul_i32 s56, s56, 9
    s_sub_u32 s98, s98, s56
    s_and_b32 s45, s98, 31
    ds_write_b128 v123, v[136:139] offset:16384
    ds_write_b128 v123, v[136:139] offset:16512
    v_lshrrev_b32 v121, 3, v0
    v_and_b32 v122, 7, v0
    v_bfe_u32 v123, v0, 4, 3
    v_xor_b32 v123, v123, v122
    v_lshlrev_b32 v123, 4, v123
    v_mul_u32_u24 v1, 2304, v121
    v_add_u32 v1, v1, v123
    v_add_u32 v2, 73728, v1
    v_and_b32 v124, 15, v121
    v_mul_u32_u24 v124, 2304, v124
    v_add_u32 v124, 147456, v124
    v_add_u32 v3, v124, v123
    v_and_b32 v123, 2, v121
    v_lshrrev_b32 v124, 1, v121
    v_and_or_b32 v123, v124, 4, v123
    v_xor_b32 v123, v123, v122
    v_lshlrev_b32 v123, 4, v123
    v_mul_u32_u24 v4, 3456, v121
    v_add_u32 v4, v4, v123
    v_add_u32 v5, 110592, v4
    s_lshl_b32 s41, s40, 10
    s_and_b32 s50, s41, 1024
    s_lshr_b32 s49, s40, 1
    s_lshl_b32 s46, s45, 7
    s_mul_i32 s72, s45, 221184
    s_mov_b32 s7, 0x20000
    s_mov_b32 s11, 0x20000
    s_sub_u32 s6, 2359296, s54
    s_sub_u32 s10, 1990656, s55
    s_mov_b32 s4, s54
    s_add_u32 m0, s50, 8192
    s_waitcnt lgkmcnt(0)
    s_add_u32 s4, s28, s4
    s_addc_u32 s5, s29, 0
    s_cmp_lg_u32 s49, 0
    s_cbranch_scc1 L_xo_1
    buffer_load_dwordx4 v3, s[4:7], s46 offen lds
L_xo_1:
    s_add_u32 m0, s41, 0
    s_add_u32 s8, s30, s55
    s_addc_u32 s9, s31, 0
    buffer_load_dwordx4 v1, s[4:7], s46 offen lds
    s_add_u32 m0, s41, 10240
    v_and_b32 v127, 63, v0
    buffer_load_dwordx4 v4, s[8:11], s72 offen lds
    s_add_u32 m0, s41, 17280
    v_bfe_u32 v128, v0, 4, 2
    buffer_load_dwordx4 v4, s[8:11], s72 offen offset:1152 lds
    s_add_u32 m0, s41, 4096
    v_and_b32 v129, 15, v0
    s_cmp_eq_u32 s40, 3
    s_cselect_b32 s58, 1, 0
    v_mov_b32 v150, 0
    v_mov_b32 v151, 0
    s_add_u32 s56, s99, 0xe739ce7
    s_lshr_b32 s56, s56, 4
    s_and_b32 s56, s56, 0x2108421
    s_mul_i32 s56, s56, 9
    s_sub_u32 s99, s99, s56
    v_lshrrev_b32 v130, 1, v129
    buffer_load_dwordx4 v2, s[4:7], s46 offen lds
    s_add_u32 m0, s41, 14336
    v_xor_b32 v123, v130, v128
    v_lshlrev_b32 v123, 4, v123
    v_lshl_add_u32 v8, v129, 7, v123
    v_xor_b32 v9, 64, v8
    v_bfe_u32 v123, v0, 2, 2
    v_lshl_add_u32 v124, v128, 3, v123
    v_bfe_u32 v125, v0, 3, 2
    v_xor_b32 v125, v125, v120
    v_and_b32 v130, 3, v0
    v_lshlrev_b32 v130, 3, v130
    buffer_load_dwordx4 v5, s[8:11], s72 offen lds
    s_add_u32 m0, s41, 21376
    v_lshl_add_u32 v125, v125, 5, v130
    v_lshl_add_u32 v124, v124, 7, v125
    v_add_u32 v10, 10240, v124
    v_add_u32 v11, 18432, v124
    v_add_u32 v12, 106496, v124
    v_lshrrev_b32 v124, 1, v128
    v_lshl_add_u32 v123, v124, 4, v123
    v_and_b32 v124, 1, v128
    v_lshl_add_u32 v123, v124, 2, v123
    v_lshl_add_u32 v123, v123, 7, v125
    buffer_load_dwordx4 v5, s[8:11], s72 offen offset:1152 lds
    s_bfe_u32 s46, s98, 327685
    s_lshl_b32 s46, s46, 7
    s_mul_i32 s73, s46, 1728
    s_add_u32 m0, s50, 34816
    v_add_u32 v52, 53248, v123
    v_xor_b32 v53, 32, v52
    v_xor_b32 v54, 64, v52
    v_xor_b32 v55, 32, v54
    v_and_b32 v123, 6, v121
    v_xor_b32 v123, v123, v122
    v_lshlrev_b32 v123, 4, v123
    v_mul_u32_u24 v6, 1152, v121
    v_add_u32 v6, v6, v123
    v_add_u32 v7, 36864, v6
    s_cmp_lg_u32 s49, 1
    s_cbranch_scc1 L_xo_2
    buffer_load_dwordx4 v3, s[4:7], s46 offen lds
L_xo_2:
    s_add_u32 m0, s41, 26624
    s_lshl_b32 s48, s42, 2
    s_add_u32 s48, s48, s40
    s_mul_i32 s53, s48, 57
    s_lshr_b32 s53, s53, 9
    buffer_load_dwordx4 v1, s[4:7], s46 offen lds
    s_add_u32 m0, s41, 36864
    s_mul_i32 s53, s53, 9
    s_sub_u32 s48, s48, s53
    v_lshlrev_b32 v131, 3, v127
    v_lshlrev_b32 v123, 1, v128
    s_mul_i32 s53, s40, 5152
    s_add_u32 s53, s53, 79872
    v_cmp_le_u32 s[84:85], s48, v123
    v_add_u32 v124, s53, v131
    v_add_u32 v125, 2576, v124
    v_cndmask_b32 v13, v124, v125, s[84:85]
    buffer_load_dwordx4 v4, s[8:11], s73 offen lds
    s_add_u32 m0, s41, 43904
    v_add_u32 v123, 1, v123
    v_cmp_le_u32 s[86:87], s48, v123
    s_mul_i32 s53, s40, 2560
    v_add_u32 v15, s53, v131
    v_cndmask_b32 v14, v124, v125, s[86:87]
    v_add_u32 v14, 4, v14
    v_cmp_gt_u32 vcc, 8, v129
    v_and_b32 v123, 8, v129
    v_lshlrev_b32 v123, 6, v123
    s_lshr_b32 s53, s41, 1
    buffer_load_dwordx4 v4, s[8:11], s73 offen offset:1152 lds
    s_add_u32 m0, s41, 30720
    v_add_u32 v17, s53, v131
    s_min_u32 s54, s40, 1
    v_mul_u32_u24 v124, s54, v123
    v_sub_u32 v16, v17, v124
    v_mov_b32 v125, 82432
    v_add_u32 v124, 79872, v17
    v_cndmask_b32 v18, v125, v124, vcc
    v_cndmask_b32 v19, v124, v125, vcc
    s_min_u32 s54, s40, 2
    s_mul_i32 s53, s54, 2560
    s_add_u32 s53, s53, 2048
    v_add_u32 v21, s53, v131
    v_sub_u32 v20, v21, v123
    s_mul_i32 s53, s54, 5152
    s_add_u32 s53, s53, 84496
    v_add_u32 v124, s53, v131
    v_cndmask_b32 v22, v125, v124, vcc
    v_cndmask_b32 v23, v124, v125, vcc
    s_mul_i32 s53, s58, 7680
    s_add_u32 s53, s53, 2048
    v_add_u32 v25, s53, v131
    v_sub_u32 v24, v25, v123
    s_mul_i32 s53, s58, 18032
    s_add_u32 s53, s53, 81920
    v_add_u32 v124, s53, v131
    v_cndmask_b32 v26, v125, v124, vcc
    v_cndmask_b32 v27, v124, v125, vcc
    v_cndmask_b32 v126, -1, 0, vcc
    v_and_b32 v123, 7, v129
    v_lshlrev_b32_e64 v123, v123, 2
    v_subrev_u32 v123, 1, v123
    v_xor_b32 v123, v123, v126
    s_mov_b32 s53, 0xffff
    v_bfe_i32 v124, v123, 0, 1
    v_bfe_i32 v125, v123, 1, 1
    v_bfi_b32 v44, s53, v124, v125
    v_bfe_i32 v124, v123, 2, 1
    v_bfe_i32 v125, v123, 3, 1
    v_bfi_b32 v45, s53, v124, v125
    v_bfe_i32 v124, v123, 4, 1
    v_bfe_i32 v125, v123, 5, 1
    v_bfi_b32 v46, s53, v124, v125
    v_bfe_i32 v124, v123, 6, 1
    v_bfe_i32 v125, v123, 7, 1
    v_bfi_b32 v47, s53, v124, v125
    s_mul_i32 s53, s83, 7
    s_add_u32 s53, s53, s43
    s_mul_i32 s53, s53, 123392
    s_mov_b64 s[26:27], s[36:37]
    s_add_u32 s20, s38, s53
    s_addc_u32 s21, s39, 0
    s_mov_b32 s22, 123392
    s_mov_b32 s23, 0x20000
    v_and_b32 v123, 32, v0
    v_lshlrev_b32 v123, 6, v123
    v_and_b32 v124, 31, v0
    v_lshl_add_u32 v123, v124, 4, v123
    v_lshl_add_u32 v123, v120, 9, v123
    v_add_u32 v39, 131072, v123
    s_mul_i32 s53, s42, 10496
    v_cmp_gt_u32 vcc, 32, v127
    v_add_u32 v37, s53, v123
    v_mov_b32 v126, 1073741824
    v_cndmask_b32 v38, v126, v37, vcc
    s_add_u32 s53, s53, 10240
    v_cmp_eq_u32 vcc, 0, v129
    v_add_u32 v123, s53, v0
    s_movk_i32 s51, 4096
    s_movk_i32 s52, 8192
    v_cndmask_b32 v42, v126, v123, vcc
    v_cmp_eq_u32 vcc, 1, v128
    v_mov_b32 v123, s58
    v_lshrrev_b32 v125, 1, v128
    v_cndmask_b32 v123, v125, v123, vcc
    v_cndmask_b32 v124, v120, 4, vcc
    s_add_u32 s53, s40, 1
    s_bitcmp0_b32 s53, 1
    s_cselect_b32 s56, -1, 0xffff
    s_mov_b32 s57, 0xffff
    v_mad_u32_u24 v125, v123, 20, v124
    v_cndmask_b32 v125, 25, v125, s[56:57]
    v_mul_u32_u24 v125, 528, v125
    v_lshl_add_u32 v125, v129, 4, v125
    v_add_u32 v28, 26624, v125
    v_lshl_add_u32 v125, v123, 1, s42
    v_subrev_u32 v125, 1, v125
    v_cmp_gt_u32 vcc, 9, v125
    v_mul_u32_u24 v124, 320, v124
    v_add_u32 v124, 94464, v124
    s_and_b64 s[24:25], vcc, s[56:57]
    v_mul_u32_u24 v123, 1600, v123
    v_mul_u32_u24 v125, 3200, v125
    v_sub_u32 v125, v125, v123
    v_add_u32 v125, 1600, v125
    v_add_u32 v125, v125, v124
    s_mul_i32 s53, s42, 3200
    v_add3_u32 v123, v123, v124, s53
    v_cndmask_b32 v123, v126, v123, s[24:25]
    v_cndmask_b32 v125, v126, v125, s[24:25]
    v_lshl_add_u32 v35, v129, 4, v123
    v_lshl_add_u32 v60, v129, 2, v123
    v_lshl_add_u32 v36, v129, 4, v125
    buffer_load_dwordx4 v2, s[4:7], s46 offen lds
    s_add_u32 m0, s41, 40960
    v_lshl_add_u32 v61, v129, 2, v125
    v_lshlrev_b32 v123, 1, v128
    v_lshrrev_b32 v124, 1, v128
    v_or_b32 v123, v123, v124
    v_and_b32 v123, 3, v123
    v_mad_u32_u24 v123, v123, 5, v120
    s_mul_i32 s53, s40, 5
    s_add_u32 s53, s53, 4
    s_add_u32 s53, s53, s58
    v_cmp_eq_u32 vcc, 3, v128
    v_mov_b32 v124, s53
    v_min_u32 v125, 25, v127
    v_cndmask_b32 v123, v123, v124, vcc
    v_mul_u32_u24 v123, 528, v123
    v_lshl_add_u32 v123, v129, 4, v123
    v_add_u32 v29, 29264, v123
    v_mul_u32_u24 v125, 528, v125
    v_add_u32 v34, 27136, v125
    v_and_b32 v123, 1, v128
    v_lshlrev_b32 v123, 3, v123
    v_lshl_add_u32 v123, v129, 4, v123
    v_lshrrev_b32 v124, 1, v128
    v_lshl_add_u32 v123, v124, 8, v123
    s_mov_b32 s56, 0
    s_mov_b32 s57, 0x00ff00ff
    v_mov_b32 v124, 512
    v_cndmask_b32 v125, v123, v124, s[56:57]
    v_cndmask_b32 v124, v124, v123, s[56:57]
    s_max_u32 s53, s40, 1
    s_mul_i32 s53, s53, 2640
    buffer_load_dwordx4 v5, s[8:11], s73 offen lds
    s_add_u32 m0, s41, 48000
    s_add_u32 s53, s53, 26624
    v_add_u32 v30, s53, v125
    v_add_u32 v31, s53, v124
    s_cmp_eq_u32 s40, 0
    s_movk_i32 s54, 2640
    s_cselect_b32 s54, -2640, s54
    v_add_u32 v32, s54, v30
    v_add_u32 v33, s54, v31
    s_cselect_b32 s57, s57, 0
    s_cselect_b64 s[70:71], -1, 0
    v_mov_b32 v123, 0xf149f2ca
    v_cndmask_b32 v48, 0, v123, s[56:57]
    v_lshrrev_b32 v124, 1, v129
    v_cmp_gt_u32 vcc, s48, v124
    s_nop 1
    s_xor_b64 s[84:85], vcc, s[70:71]
    s_movk_i32 s70, 0x3f80
    s_mov_b32 s71, 1.0
    v_mov_b32 v49, v48
    v_mov_b32 v50, v48
    v_mov_b32 v51, v48
    s_mov_b32 s60, 0xff000ff
    s_mov_b32 s61, s60
    s_mov_b32 s62, 0x1fe001fe
    s_mov_b32 s63, s62
    s_mov_b32 s64, 0x3fc003fc
    s_mov_b32 s65, s64
    s_mov_b32 s66, 0x7f8007f8
    s_mov_b32 s67, s66
    s_mov_b32 s68, 0x3eae1a93
    s_mov_b32 s69, s68
    s_mov_b32 s59, 524288
    s_add_u32 s12, s32, s55
    s_addc_u32 s13, s33, 0
    s_sub_u32 s14, 663552, s55
    s_mov_b32 s15, 0x20000
    s_mov_b32 s3, 0
    v_mad_u32_u24 v123, v120, 21, v127
    buffer_load_dwordx4 v5, s[8:11], s73 offen offset:1152 lds
    v_mad_u32_u24 v123, v123, 7, s43
    v_mul_u32_u24 v149, 1152, v123
    s_sub_u32 s53, 8, s42
    s_min_u32 s54, s53, s42
    s_and_b32 s56, s54, 3
    s_mul_i32 s56, s56, 0x11110111
    s_xor_b32 s56, s56, 0x32104321
    s_and_b32 s54, s54, 4
    s_lshl_b32 s54, s54, 12
    s_xor_b32 s56, s56, s54
    s_bfe_u32 s46, s98, 327690
    s_lshl_b32 s46, s46, 7
    s_mul_i32 s74, s46, 1728
    s_add_u32 m0, s50, 61440
    s_waitcnt vmcnt(6) lgkmcnt(0)
    s_barrier
    ds_read_b64_tr_b16 v[64:65], v10 offset:0
    ds_read_b64_tr_b16 v[66:67], v10 offset:512
    ds_read_b128 a[0:3], v8 offset:0
    ds_read_b64_tr_b16 v[68:69], v11 offset:0
    ds_read_b64_tr_b16 v[70:71], v11 offset:512
    ds_read_b128 a[4:7], v8 offset:2048
    ds_read_b128 a[8:11], v8 offset:4096
    s_cmp_lg_u32 s49, 0
    s_cbranch_scc1 L_xo_3
    buffer_load_dwordx4 v3, s[4:7], s46 offen lds
L_xo_3:
    ds_read_b128 a[12:15], v8 offset:6144
    ds_read_b128 a[16:19], v8 offset:8192
    s_waitcnt lgkmcnt(6)
    v_mfma_f32_16x16x32_bf16 v[80:83], v[64:67], a[0:3], 0
    s_add_u32 m0, s41, 53248
    ds_read_b64_tr_b16 v[72:73], v10 offset:4096
    ds_read_b64_tr_b16 v[74:75], v10 offset:4608
    s_waitcnt lgkmcnt(6)
    v_mfma_f32_16x16x32_bf16 v[100:103], v[68:71], a[0:3], 0
    buffer_load_dwordx4 v1, s[4:7], s46 offen lds
    ds_read_b128 a[20:23], v9 offset:0
    s_waitcnt lgkmcnt(6)
    v_mfma_f32_16x16x32_bf16 v[84:87], v[64:67], a[4:7], 0
    s_add_u32 m0, s41, 63488
    ds_read_b64_tr_b16 v[76:77], v11 offset:4096
    ds_read_b64_tr_b16 v[78:79], v11 offset:4608
    v_mfma_f32_16x16x32_bf16 v[104:107], v[68:71], a[4:7], 0
    buffer_load_dwordx4 v4, s[8:11], s74 offen lds
    ds_read_b128 a[24:27], v9 offset:2048
    s_waitcnt lgkmcnt(8)
    v_mfma_f32_16x16x32_bf16 v[88:91], v[64:67], a[8:11], 0
    s_add_u32 m0, s41, 70528
    ds_read_b128 a[28:31], v9 offset:4096
    v_mfma_f32_16x16x32_bf16 v[108:111], v[68:71], a[8:11], 0
    buffer_load_dwordx4 v4, s[8:11], s74 offen offset:1152 lds
    ds_read_b128 a[32:35], v9 offset:6144
    s_waitcnt lgkmcnt(9)
    v_mfma_f32_16x16x32_bf16 v[92:95], v[64:67], a[12:15], 0
    s_add_u32 m0, s41, 57344
    ds_read_b128 a[36:39], v9 offset:8192
    v_mfma_f32_16x16x32_bf16 v[112:115], v[68:71], a[12:15], 0
    buffer_load_dwordx4 v2, s[4:7], s46 offen lds
    s_add_u32 m0, s41, 67584
    s_waitcnt lgkmcnt(9)
    v_mfma_f32_16x16x32_bf16 v[96:99], v[64:67], a[16:19], 0
    buffer_load_dwordx4 v5, s[8:11], s74 offen lds
    s_add_u32 m0, s41, 74624
    v_mfma_f32_16x16x32_bf16 v[116:119], v[68:71], a[16:19], 0
    buffer_load_dwordx4 v5, s[8:11], s74 offen offset:1152 lds
    s_bfe_u32 s46, s98, 327695
    s_lshl_b32 s46, s46, 7
    s_mul_i32 s75, s46, 1728
    s_add_u32 m0, s50, 8192
    s_branch L_main
L_go_retry:
    s_cmp_eq_u32 s59, 0
    s_cbranch_scc1 L_go_ok
    s_sub_u32 s59, s59, 1
    s_nop 7
    global_load_dword v63, v150, s[26:27] sc1
    s_waitcnt vmcnt(0)
    v_cmp_eq_u32 vcc, 0, v63
    s_cbranch_vccnz L_go_retry
    s_branch L_go_ok
L_rx_retry:
    s_cmp_eq_u32 s59, 0
    s_cbranch_scc1 L_rx_ok
    s_sub_u32 s59, s59, 1
    s_nop 7
    buffer_load_dwordx4 v[68:71], v36, s[20:23], 0 offen sc1
    buffer_load_dword v76, v61, s[20:23], 0 offen offset:256 sc1
    s_waitcnt vmcnt(0)
    v_add3_u32 v140, v68, v69, v70
    v_add3_u32 v140, v140, v71, v62
    v_cmp_ne_u32 vcc, v76, v140
    s_cbranch_vccnz L_rx_retry
    s_branch L_rx_ok
L_agent:
    s_lshl2_add_u32 s58, s83, s40
    s_cmp_lg_u32 s58, 4
    s_cbranch_scc1 L_agent_pf
    v_min_u32 v6, 27, v0
    v_mul_u32_u24 v6, 123392, v6
    v_add_u32 v6, 123264, v6
    v_mul_u32_u24 v5, 0x9e3778, v0
    v_add_u32 v5, 0x85ebca6b, v5
    v_mov_b32 v1, 0
    s_waitcnt lgkmcnt(0)
    global_load_dword v7, v6, s[38:39] sc1
    s_waitcnt vmcnt(0)
    v_lshrrev_b32 v3, 15, v7
    v_xor_b32 v4, v7, v3
    v_mul_lo_u32 v4, v4, v5
    v_lshrrev_b32 v3, 13, v4
    v_xor_b32 v4, v4, v3
    s_nop 1
    v_add_u32_dpp v4, v4, v4 row_ror:8 row_mask:0xf bank_mask:0xf
    s_nop 1
    v_add_u32_dpp v4, v4, v4 row_ror:4 row_mask:0xf bank_mask:0xf
    s_nop 1
    v_add_u32_dpp v4, v4, v4 row_ror:2 row_mask:0xf bank_mask:0xf
    s_nop 1
    v_add_u32_dpp v4, v4, v4 row_ror:1 row_mask:0xf bank_mask:0xf
    s_nop 0
    v_readlane_b32 s53, v4, 0
    v_readlane_b32 s54, v4, 16
    v_readlane_b32 s55, v4, 32
    v_readlane_b32 s56, v4, 48
    s_add_u32 s53, s53, s54
    s_nop 0
    s_add_u32 s55, s55, s56
    s_add_u32 s53, s53, s55
    s_add_u32 s53, s53, 0x7f4a7c15
    s_mul_i32 s53, s53, 0xc2b2ae35
    s_lshr_b32 s54, s53, 16
    s_xor_b32 s53, s53, s54
    s_or_b32 s53, s53, 1
L_tag:
    s_add_u32 s53, s53, 2
    v_cmp_eq_u32 vcc, s53, v7
    s_cbranch_vccnz L_tag
    v_mov_b32 v2, s53
    s_mov_b64 exec, 1
    global_store_dword v1, v2, s[36:37] sc1
    s_mov_b64 exec, 0xfffffff
    global_store_dword v6, v2, s[38:39] sc1
    s_mov_b64 exec, -1
L_agent_pf:
    s_endpgm
.p2align 12
L_main:
    s_waitcnt vmcnt(6) lgkmcnt(0)
    s_barrier
    s_cmp_lg_u32 s49, 1
    s_cbranch_scc1 L_xo_4
    buffer_load_dwordx4 v3, s[4:7], s46 offen lds
L_xo_4:
    v_mfma_f32_16x16x32_bf16 v[80:83], v[72:75], a[20:23], v[80:83]
    s_add_u32 m0, s41, 0
    ds_read_b64_tr_b16 v[64:65], v10 offset:26624
    ds_read_b64_tr_b16 v[66:67], v10 offset:27136
    v_mfma_f32_16x16x32_bf16 v[100:103], v[76:79], a[20:23], v[100:103]
    buffer_load_dwordx4 v1, s[4:7], s46 offen lds
    ds_read_b128 a[40:43], v8 offset:26624
    v_mfma_f32_16x16x32_bf16 v[84:87], v[72:75], a[24:27], v[84:87]
    ds_read_b64_tr_b16 v[68:69], v11 offset:26624
    ds_read_b64_tr_b16 v[70:71], v11 offset:27136
    v_mfma_f32_16x16x32_bf16 v[104:107], v[76:79], a[24:27], v[104:107]
    s_add_u32 m0, s41, 10240
    ds_read_b128 a[44:47], v8 offset:28672
    s_add_u32 s56, s56, 0x55550000
    v_mfma_f32_16x16x32_bf16 v[88:91], v[72:75], a[28:31], v[88:91]
    buffer_load_dwordx4 v4, s[8:11], s75 offen lds
    ds_read_b128 a[48:51], v8 offset:30720
    v_mfma_f32_16x16x32_bf16 v[108:111], v[76:79], a[28:31], v[108:111]
    ds_read_b128 a[52:55], v8 offset:32768
    s_sub_u32 s53, 0x88888888, s56
    v_mfma_f32_16x16x32_bf16 v[92:95], v[72:75], a[32:35], v[92:95]
    s_add_u32 m0, s41, 17280
    ds_read_b128 a[56:59], v8 offset:34816
    s_cmp_eq_u32 s47, 0
    s_cselect_b32 s28, s56, s53
    v_mfma_f32_16x16x32_bf16 v[112:115], v[76:79], a[32:35], v[112:115]
    buffer_load_dwordx4 v4, s[8:11], s75 offen offset:1152 lds
    ds_read_b128 a[60:63], v9 offset:26624
    v_mfma_f32_16x16x32_bf16 v[96:99], v[72:75], a[36:39], v[96:99]
    ds_read_b128 a[64:67], v9 offset:28672
    s_sub_u32 s18, s6, s55
    v_mfma_f32_16x16x32_bf16 v[116:119], v[76:79], a[36:39], v[116:119]
    s_add_u32 m0, s41, 4096
    ds_read_b128 a[68:71], v9 offset:30720
    s_waitcnt lgkmcnt(3)
    v_mfma_f32_16x16x32_bf16 v[80:83], v[64:67], a[40:43], v[80:83]
    buffer_load_dwordx4 v2, s[4:7], s46 offen lds
    s_sub_u32 s54, 2359296, s18
    v_mfma_f32_16x16x32_bf16 v[100:103], v[68:71], a[40:43], v[100:103]
    ds_read_b64_tr_b16 v[72:73], v10 offset:30720
    ds_read_b64_tr_b16 v[74:75], v10 offset:31232
    v_mfma_f32_16x16x32_bf16 v[84:87], v[64:67], a[44:47], v[84:87]
    s_add_u32 m0, s41, 14336
    ds_read_b64_tr_b16 v[76:77], v11 offset:30720
    ds_read_b64_tr_b16 v[78:79], v11 offset:31232
    v_mfma_f32_16x16x32_bf16 v[104:107], v[68:71], a[44:47], v[104:107]
    buffer_load_dwordx4 v5, s[8:11], s75 offen lds
    ds_read_b128 a[72:75], v9 offset:32768
    v_mfma_f32_16x16x32_bf16 v[88:91], v[64:67], a[48:51], v[88:91]
    ds_read_b128 a[76:79], v9 offset:34816
    s_add_u32 s16, s34, s54
    s_addc_u32 s17, s35, 0
    v_mfma_f32_16x16x32_bf16 v[108:111], v[68:71], a[48:51], v[108:111]
    s_add_u32 m0, s41, 21376
    s_mov_b32 s19, 0x20000
    v_lshlrev_b32 v123, 4, v127
    v_mfma_f32_16x16x32_bf16 v[92:95], v[64:67], a[52:55], v[92:95]
    buffer_load_dwordx4 v5, s[8:11], s75 offen offset:1152 lds
    v_lshl_add_u32 v40, v120, 11, v123
    v_mfma_f32_16x16x32_bf16 v[112:115], v[68:71], a[52:55], v[112:115]
    s_bfe_u32 s46, s98, 327700
    s_lshl_b32 s46, s46, 7
    v_add_u32 v41, 8192, v123
    v_mfma_f32_16x16x32_bf16 v[96:99], v[64:67], a[56:59], v[96:99]
    s_mul_i32 s76, s46, 1728
    v_mfma_f32_16x16x32_bf16 v[116:119], v[68:71], a[56:59], v[116:119]
    s_add_u32 m0, s50, 34816
    s_waitcnt vmcnt(6) lgkmcnt(0)
    s_barrier
    s_cmp_lg_u32 s49, 0
    s_cbranch_scc1 L_xo_5
    buffer_load_dwordx4 v3, s[4:7], s46 offen lds
L_xo_5:
    v_mfma_f32_16x16x32_bf16 v[80:83], v[72:75], a[60:63], v[80:83]
    s_add_u32 m0, s41, 26624
    ds_read_b64_tr_b16 v[64:65], v10 offset:53248
    ds_read_b64_tr_b16 v[66:67], v10 offset:53760
    v_mfma_f32_16x16x32_bf16 v[100:103], v[76:79], a[60:63], v[100:103]
    buffer_load_dwordx4 v1, s[4:7], s46 offen lds
    ds_read_b128 a[80:83], v8 offset:53248
    v_mfma_f32_16x16x32_bf16 v[84:87], v[72:75], a[64:67], v[84:87]
    ds_read_b64_tr_b16 v[68:69], v11 offset:53248
    ds_read_b64_tr_b16 v[70:71], v11 offset:53760
    v_mfma_f32_16x16x32_bf16 v[104:107], v[76:79], a[64:67], v[104:107]
    s_add_u32 m0, s41, 36864
    ds_read_b128 a[84:87], v8 offset:55296
    v_bfe_u32 v123, v0, 3, 3
    v_mfma_f32_16x16x32_bf16 v[88:91], v[72:75], a[68:71], v[88:91]
    buffer_load_dwordx4 v4, s[8:11], s76 offen lds
    ds_read_b128 a[88:91], v8 offset:57344
    v_mfma_f32_16x16x32_bf16 v[108:111], v[76:79], a[68:71], v[108:111]
    ds_read_b128 a[92:95], v8 offset:59392
    v_xor_b32 v124, v123, v122
    v_mfma_f32_16x16x32_bf16 v[92:95], v[72:75], a[72:75], v[92:95]
    s_add_u32 m0, s41, 43904
    ds_read_b128 a[96:99], v8 offset:61440
    v_lshlrev_b32 v124, 4, v124
    v_mfma_f32_16x16x32_bf16 v[112:115], v[76:79], a[72:75], v[112:115]
    buffer_load_dwordx4 v4, s[8:11], s76 offen offset:1152 lds
    ds_read_b128 a[100:103], v9 offset:53248
    v_mfma_f32_16x16x32_bf16 v[96:99], v[72:75], a[76:79], v[96:99]
    ds_read_b128 a[104:107], v9 offset:55296
    v_lshl_add_u32 v123, v120, 4, v123
    v_mfma_f32_16x16x32_bf16 v[116:119], v[76:79], a[76:79], v[116:119]
    s_add_u32 m0, s41, 30720
    ds_read_b128 a[108:111], v9 offset:57344
    s_waitcnt lgkmcnt(3)
    v_mfma_f32_16x16x32_bf16 v[80:83], v[64:67], a[80:83], v[80:83]
    buffer_load_dwordx4 v2, s[4:7], s46 offen lds
    v_lshl_add_u32 v59, v123, 7, v124
    v_mfma_f32_16x16x32_bf16 v[100:103], v[68:71], a[80:83], v[100:103]
    ds_read_b64_tr_b16 v[72:73], v10 offset:57344
    ds_read_b64_tr_b16 v[74:75], v10 offset:57856
    v_mfma_f32_16x16x32_bf16 v[84:87], v[64:67], a[84:87], v[84:87]
    s_add_u32 m0, s41, 40960
    ds_read_b64_tr_b16 v[76:77], v11 offset:57344
    ds_read_b64_tr_b16 v[78:79], v11 offset:57856
    v_mfma_f32_16x16x32_bf16 v[104:107], v[68:71], a[84:87], v[104:107]
    buffer_load_dwordx4 v5, s[8:11], s76 offen lds
    ds_read_b128 a[112:115], v9 offset:59392
    v_mfma_f32_16x16x32_bf16 v[88:91], v[64:67], a[88:91], v[88:91]
    ds_read_b128 a[116:119], v9 offset:61440
    s_min_u32 s53, s44, 1
    v_mfma_f32_16x16x32_bf16 v[108:111], v[68:71], a[88:91], v[108:111]
    s_add_u32 m0, s41, 48000
    s_mul_i32 s53, s53, 7
    v_cmp_le_u32 vcc, s53, v123
    v_mfma_f32_16x16x32_bf16 v[92:95], v[64:67], a[92:95], v[92:95]
    buffer_load_dwordx4 v5, s[8:11], s76 offen offset:1152 lds
    v_mul_u32_u24 v123, 2304, v123
    v_mfma_f32_16x16x32_bf16 v[112:115], v[68:71], a[92:95], v[112:115]
    s_bfe_u32 s46, s98, 327705
    s_lshl_b32 s46, s46, 7
    v_lshl_add_u32 v123, v122, 4, v123
    v_mfma_f32_16x16x32_bf16 v[96:99], v[64:67], a[96:99], v[96:99]
    s_mul_i32 s77, s46, 1728
    v_mfma_f32_16x16x32_bf16 v[116:119], v[68:71], a[96:99], v[116:119]
    s_add_u32 m0, s50, 61440
    s_waitcnt vmcnt(6) lgkmcnt(0)
    s_barrier
    s_cmp_lg_u32 s49, 1
    s_cbranch_scc1 L_xo_6
    buffer_load_dwordx4 v3, s[4:7], s46 offen lds
L_xo_6:
    v_mfma_f32_16x16x32_bf16 v[80:83], v[72:75], a[100:103], v[80:83]
    s_add_u32 m0, s41, 53248
    ds_read_b64_tr_b16 v[64:65], v10 offset:0
    ds_read_b64_tr_b16 v[66:67], v10 offset:512
    v_mfma_f32_16x16x32_bf16 v[100:103], v[76:79], a[100:103], v[100:103]
    buffer_load_dwordx4 v1, s[4:7], s46 offen lds
    ds_read_b128 a[120:123], v8 offset:0
    v_mfma_f32_16x16x32_bf16 v[84:87], v[72:75], a[104:107], v[84:87]
    ds_read_b64_tr_b16 v[68:69], v11 offset:0
    ds_read_b64_tr_b16 v[70:71], v11 offset:512
    v_mfma_f32_16x16x32_bf16 v[104:107], v[76:79], a[104:107], v[104:107]
    s_add_u32 m0, s41, 63488
    ds_read_b128 a[124:127], v8 offset:2048
    v_mov_b32 v126, 1073741824
    v_mfma_f32_16x16x32_bf16 v[88:91], v[72:75], a[108:111], v[88:91]
    buffer_load_dwordx4 v4, s[8:11], s77 offen lds
    ds_read_b128 a[128:131], v8 offset:4096
    v_mfma_f32_16x16x32_bf16 v[108:111], v[76:79], a[108:111], v[108:111]
    ds_read_b128 a[132:135], v8 offset:6144
    v_add_u32 v57, 18432, v123
    v_mfma_f32_16x16x32_bf16 v[92:95], v[72:75], a[112:115], v[92:95]
    s_add_u32 m0, s41, 70528
    ds_read_b128 a[136:139], v8 offset:8192
    v_cndmask_b32 v56, v126, v123, vcc
    v_mfma_f32_16x16x32_bf16 v[112:115], v[76:79], a[112:115], v[112:115]
    buffer_load_dwordx4 v4, s[8:11], s77 offen offset:1152 lds
    ds_read_b128 a[140:143], v9 offset:0
    v_mfma_f32_16x16x32_bf16 v[96:99], v[72:75], a[116:119], v[96:99]
    ds_read_b128 a[144:147], v9 offset:2048
    v_lshrrev_b32 v123, 4, v0
    v_mfma_f32_16x16x32_bf16 v[116:119], v[76:79], a[116:119], v[116:119]
    s_add_u32 m0, s41, 57344
    ds_read_b128 a[148:151], v9 offset:4096
    s_waitcnt lgkmcnt(3)
    v_mfma_f32_16x16x32_bf16 v[80:83], v[64:67], a[120:123], v[80:83]
    buffer_load_dwordx4 v2, s[4:7], s46 offen lds
    v_add_u32 v123, 64, v123
    v_mfma_f32_16x16x32_bf16 v[100:103], v[68:71], a[120:123], v[100:103]
    ds_read_b64_tr_b16 v[72:73], v10 offset:4096
    ds_read_b64_tr_b16 v[74:75], v10 offset:4608
    v_mfma_f32_16x16x32_bf16 v[84:87], v[64:67], a[124:127], v[84:87]
    s_add_u32 m0, s41, 67584
    ds_read_b64_tr_b16 v[76:77], v11 offset:4096
    ds_read_b64_tr_b16 v[78:79], v11 offset:4608
    v_mfma_f32_16x16x32_bf16 v[104:107], v[68:71], a[124:127], v[104:107]
    buffer_load_dwordx4 v5, s[8:11], s77 offen lds
    ds_read_b128 a[152:155], v9 offset:6144
    v_mfma_f32_16x16x32_bf16 v[88:91], v[64:67], a[128:131], v[88:91]
    ds_read_b128 a[156:159], v9 offset:8192
    v_mul_u32_u24 v123, 2304, v123
    v_mfma_f32_16x16x32_bf16 v[108:111], v[68:71], a[128:131], v[108:111]
    s_add_u32 m0, s41, 74624
    v_lshl_add_u32 v58, v129, 3, v123
    s_lshl_b32 s53, s40, 3
    v_mfma_f32_16x16x32_bf16 v[92:95], v[64:67], a[132:135], v[92:95]
    buffer_load_dwordx4 v5, s[8:11], s77 offen offset:1152 lds
    s_lshr_b32 s53, s28, s53
    v_mfma_f32_16x16x32_bf16 v[112:115], v[68:71], a[132:135], v[112:115]
    s_bfe_u32 s46, s99, 327680
    s_lshl_b32 s46, s46, 7
    s_and_b32 s81, s53, 15
    v_mfma_f32_16x16x32_bf16 v[96:99], v[64:67], a[136:139], v[96:99]
    s_mul_i32 s78, s46, 1728
    global_load_dword v63, v150, s[26:27] sc1
    v_mfma_f32_16x16x32_bf16 v[116:119], v[68:71], a[136:139], v[116:119]
    s_add_u32 m0, s50, 8192
    s_waitcnt vmcnt(7) lgkmcnt(0)
    s_barrier
    s_cmp_lg_u32 s49, 0
    s_cbranch_scc1 L_xo_7
    buffer_load_dwordx4 v3, s[4:7], s46 offen lds
L_xo_7:
    v_mfma_f32_16x16x32_bf16 v[80:83], v[72:75], a[140:143], v[80:83]
    s_add_u32 m0, s41, 0
    ds_read_b64_tr_b16 v[64:65], v10 offset:26624
    ds_read_b64_tr_b16 v[66:67], v10 offset:27136
    v_mfma_f32_16x16x32_bf16 v[100:103], v[76:79], a[140:143], v[100:103]
    buffer_load_dwordx4 v1, s[4:7], s46 offen lds
    ds_read_b128 a[160:163], v8 offset:26624
    v_mfma_f32_16x16x32_bf16 v[84:87], v[72:75], a[144:147], v[84:87]
    ds_read_b64_tr_b16 v[68:69], v11 offset:26624
    ds_read_b64_tr_b16 v[70:71], v11 offset:27136
    v_mfma_f32_16x16x32_bf16 v[104:107], v[76:79], a[144:147], v[104:107]
    s_add_u32 m0, s41, 10240
    ds_read_b128 a[164:167], v8 offset:28672
    s_bfe_u32 s82, s53, 262148
    v_mfma_f32_16x16x32_bf16 v[88:91], v[72:75], a[148:151], v[88:91]
    buffer_load_dwordx4 v4, s[8:11], s78 offen lds
    ds_read_b128 a[168:171], v8 offset:30720
    v_mfma_f32_16x16x32_bf16 v[108:111], v[76:79], a[148:151], v[108:111]
    ds_read_b128 a[172:175], v8 offset:32768
    s_mulk_i32 s81, 10496
    v_mfma_f32_16x16x32_bf16 v[92:95], v[72:75], a[152:155], v[92:95]
    s_add_u32 m0, s41, 17280
    ds_read_b128 a[176:179], v8 offset:34816
    s_mulk_i32 s82, 10496
    v_mfma_f32_16x16x32_bf16 v[112:115], v[76:79], a[152:155], v[112:115]
    buffer_load_dwordx4 v4, s[8:11], s78 offen offset:1152 lds
    ds_read_b128 a[180:183], v9 offset:26624
    v_mfma_f32_16x16x32_bf16 v[96:99], v[72:75], a[156:159], v[96:99]
    ds_read_b128 a[184:187], v9 offset:28672
    s_lshl_b32 s53, s53, 16
    v_mfma_f32_16x16x32_bf16 v[116:119], v[76:79], a[156:159], v[116:119]
    s_add_u32 m0, s41, 4096
    ds_read_b128 a[188:191], v9 offset:30720
    s_waitcnt lgkmcnt(3)
    v_mfma_f32_16x16x32_bf16 v[80:83], v[64:67], a[160:163], v[80:83]
    buffer_load_dwordx4 v2, s[4:7], s46 offen lds
    s_and_b32 s56, s28, 65535
    v_mfma_f32_16x16x32_bf16 v[100:103], v[68:71], a[160:163], v[100:103]
    ds_read_b64_tr_b16 v[72:73], v10 offset:30720
    ds_read_b64_tr_b16 v[74:75], v10 offset:31232
    v_mfma_f32_16x16x32_bf16 v[84:87], v[64:67], a[164:167], v[84:87]
    s_add_u32 m0, s41, 14336
    ds_read_b64_tr_b16 v[76:77], v11 offset:30720
    ds_read_b64_tr_b16 v[78:79], v11 offset:31232
    v_mfma_f32_16x16x32_bf16 v[104:107], v[68:71], a[164:167], v[104:107]
    buffer_load_dwordx4 v5, s[8:11], s78 offen lds
    ds_read_b128 a[192:195], v9 offset:32768
    v_mfma_f32_16x16x32_bf16 v[88:91], v[64:67], a[168:171], v[88:91]
    ds_read_b128 a[196:199], v9 offset:34816
    s_or_b32 s56, s56, s53
    v_mfma_f32_16x16x32_bf16 v[108:111], v[68:71], a[168:171], v[108:111]
    s_add_u32 m0, s41, 21376
    s_lshr_b32 s57, s28, 16
    v_and_b32 v123, 1, v129
    v_mfma_f32_16x16x32_bf16 v[92:95], v[64:67], a[172:175], v[92:95]
    buffer_load_dwordx4 v5, s[8:11], s78 offen offset:1152 lds
    v_lshlrev_b32 v123, 7, v123
    v_mfma_f32_16x16x32_bf16 v[112:115], v[68:71], a[172:175], v[112:115]
    s_bfe_u32 s46, s99, 327685
    s_lshl_b32 s46, s46, 7
    v_lshl_add_u32 v123, v128, 4, v123
    v_mfma_f32_16x16x32_bf16 v[96:99], v[64:67], a[176:179], v[96:99]
    s_mul_i32 s79, s46, 1728
    v_mfma_f32_16x16x32_bf16 v[116:119], v[68:71], a[176:179], v[116:119]
    s_add_u32 m0, s50, 34816
    s_waitcnt vmcnt(7) lgkmcnt(0)
    s_barrier
    s_cmp_lg_u32 s49, 1
    s_cbranch_scc1 L_xo_8
    buffer_load_dwordx4 v3, s[4:7], s46 offen lds
L_xo_8:
    v_mfma_f32_16x16x32_bf16 v[80:83], v[72:75], a[180:183], v[80:83]
    s_add_u32 m0, s41, 26624
    ds_read_b64_tr_b16 v[64:65], v10 offset:53248
    ds_read_b64_tr_b16 v[66:67], v10 offset:53760
    v_mfma_f32_16x16x32_bf16 v[100:103], v[76:79], a[180:183], v[100:103]
    buffer_load_dwordx4 v1, s[4:7], s46 offen lds
    ds_read_b128 a[200:203], v8 offset:53248
    v_mfma_f32_16x16x32_bf16 v[84:87], v[72:75], a[184:187], v[84:87]
    ds_read_b64_tr_b16 v[68:69], v11 offset:53248
    ds_read_b64_tr_b16 v[70:71], v11 offset:53760
    v_mfma_f32_16x16x32_bf16 v[104:107], v[76:79], a[184:187], v[104:107]
    s_add_u32 m0, s41, 36864
    ds_read_b128 a[204:207], v8 offset:55296
    v_and_b32 v124, 32, v0
    v_mfma_f32_16x16x32_bf16 v[88:91], v[72:75], a[188:191], v[88:91]
    buffer_load_dwordx4 v4, s[8:11], s79 offen lds
    ds_read_b128 a[208:211], v8 offset:57344
    v_mfma_f32_16x16x32_bf16 v[108:111], v[76:79], a[188:191], v[108:111]
    ds_read_b128 a[212:215], v8 offset:59392
    v_add_u32 v123, v123, v124
    v_mfma_f32_16x16x32_bf16 v[92:95], v[72:75], a[192:195], v[92:95]
    s_add_u32 m0, s41, 43904
    ds_read_b128 a[216:219], v8 offset:61440
    s_lshr_b32 s53, s50, 5
    v_mfma_f32_16x16x32_bf16 v[112:115], v[76:79], a[192:195], v[112:115]
    buffer_load_dwordx4 v4, s[8:11], s79 offen offset:1152 lds
    ds_read_b128 a[220:223], v9 offset:53248
    v_mfma_f32_16x16x32_bf16 v[96:99], v[72:75], a[196:199], v[96:99]
    ds_read_b128 a[224:227], v9 offset:55296
    s_lshl2_add_u32 s53, s49, s53
    v_mfma_f32_16x16x32_bf16 v[116:119], v[76:79], a[196:199], v[116:119]
    s_add_u32 m0, s41, 30720
    ds_read_b128 a[228:231], v9 offset:57344
    s_waitcnt lgkmcnt(3)
    v_mfma_f32_16x16x32_bf16 v[80:83], v[64:67], a[200:203], v[80:83]
    buffer_load_dwordx4 v2, s[4:7], s46 offen lds
    s_add_u32 s53, s53, 10240
    v_mfma_f32_16x16x32_bf16 v[100:103], v[68:71], a[200:203], v[100:103]
    ds_read_b64_tr_b16 v[72:73], v10 offset:57344
    ds_read_b64_tr_b16 v[74:75], v10 offset:57856
    v_mfma_f32_16x16x32_bf16 v[84:87], v[64:67], a[204:207], v[84:87]
    s_add_u32 m0, s41, 40960
    ds_read_b64_tr_b16 v[76:77], v11 offset:57344
    ds_read_b64_tr_b16 v[78:79], v11 offset:57856
    v_mfma_f32_16x16x32_bf16 v[104:107], v[68:71], a[204:207], v[104:107]
    buffer_load_dwordx4 v5, s[8:11], s79 offen lds
    ds_read_b128 a[232:235], v9 offset:59392
    v_mfma_f32_16x16x32_bf16 v[88:91], v[64:67], a[208:211], v[88:91]
    ds_read_b128 a[236:239], v9 offset:61440
    v_add_u32 v124, s53, v123
    v_mfma_f32_16x16x32_bf16 v[108:111], v[68:71], a[208:211], v[108:111]
    s_add_u32 m0, s41, 48000
    v_add_u32 v123, 10248, v123
    v_cmp_gt_u32 vcc, 8, v129
    v_mfma_f32_16x16x32_bf16 v[92:95], v[64:67], a[212:215], v[92:95]
    buffer_load_dwordx4 v5, s[8:11], s79 offen offset:1152 lds
    v_and_b32 v130, 14, v129
    v_mfma_f32_16x16x32_bf16 v[112:115], v[68:71], a[212:215], v[112:115]
    s_bfe_u32 s46, s99, 327690
    s_lshl_b32 s46, s46, 7
    v_lshlrev_b32 v130, 1, v130
    v_mfma_f32_16x16x32_bf16 v[96:99], v[64:67], a[216:219], v[96:99]
    s_mul_i32 s80, s46, 1728
    v_mfma_f32_16x16x32_bf16 v[116:119], v[68:71], a[216:219], v[116:119]
    s_add_u32 m0, s50, 61440
    s_waitcnt vmcnt(6) lgkmcnt(0)
    s_barrier
    s_cmp_lg_u32 s49, 0
    s_cbranch_scc1 L_xo_9
    buffer_load_dwordx4 v3, s[4:7], s46 offen lds
L_xo_9:
    v_mfma_f32_16x16x32_bf16 v[80:83], v[72:75], a[220:223], v[80:83]
    s_add_u32 m0, s41, 53248
    ds_read_b64_tr_b16 v[64:65], v10 offset:0
    ds_read_b64_tr_b16 v[66:67], v10 offset:512
    v_mfma_f32_16x16x32_bf16 v[100:103], v[76:79], a[220:223], v[100:103]
    buffer_load_dwordx4 v1, s[4:7], s46 offen lds
    ds_read_b128 a[240:243], v8 offset:0
    v_mfma_f32_16x16x32_bf16 v[84:87], v[72:75], a[224:227], v[84:87]
    ds_read_b64_tr_b16 v[68:69], v11 offset:0
    ds_read_b64_tr_b16 v[70:71], v11 offset:512
    v_mfma_f32_16x16x32_bf16 v[104:107], v[76:79], a[224:227], v[104:107]
    s_add_u32 m0, s41, 63488
    ds_read_b128 a[244:247], v8 offset:2048
    v_cndmask_b32 v123, v123, v124, vcc
    v_mfma_f32_16x16x32_bf16 v[88:91], v[72:75], a[228:231], v[88:91]
    buffer_load_dwordx4 v4, s[8:11], s80 offen lds
    ds_read_b128 a[248:251], v8 offset:4096
    v_mfma_f32_16x16x32_bf16 v[108:111], v[76:79], a[228:231], v[108:111]
    ds_read_b128 a[252:255], v8 offset:6144
    s_movk_i32 s53, 10496
    v_mfma_f32_16x16x32_bf16 v[92:95], v[72:75], a[232:235], v[92:95]
    s_add_u32 m0, s41, 70528
    ds_read_b128 v[152:155], v8 offset:8192
    v_bfe_u32 v125, s56, v130, 4
    v_mfma_f32_16x16x32_bf16 v[112:115], v[76:79], a[232:235], v[112:115]
    buffer_load_dwordx4 v4, s[8:11], s80 offen offset:1152 lds
    ds_read_b128 v[156:159], v9 offset:0
    v_mfma_f32_16x16x32_bf16 v[96:99], v[72:75], a[236:239], v[96:99]
    ds_read_b128 v[160:163], v9 offset:2048
    v_mad_u32_u24 v123, v125, s53, v123
    v_mfma_f32_16x16x32_bf16 v[116:119], v[76:79], a[236:239], v[116:119]
    s_add_u32 m0, s41, 57344
    ds_read_b128 v[164:167], v9 offset:4096
    s_waitcnt lgkmcnt(3)
    v_mfma_f32_16x16x32_bf16 v[80:83], v[64:67], a[240:243], v[80:83]
    buffer_load_dwordx4 v2, s[4:7], s46 offen lds
    v_cmp_gt_u32 s[0:1], 12, v129
    v_mfma_f32_16x16x32_bf16 v[100:103], v[68:71], a[240:243], v[100:103]
    ds_read_b64_tr_b16 v[72:73], v10 offset:4096
    ds_read_b64_tr_b16 v[74:75], v10 offset:4608
    v_mfma_f32_16x16x32_bf16 v[84:87], v[64:67], a[244:247], v[84:87]
    s_add_u32 m0, s41, 67584
    ds_read_b64_tr_b16 v[76:77], v11 offset:4096
    ds_read_b64_tr_b16 v[78:79], v11 offset:4608
    v_mfma_f32_16x16x32_bf16 v[104:107], v[68:71], a[244:247], v[104:107]
    buffer_load_dwordx4 v5, s[8:11], s80 offen lds
    ds_read_b128 v[168:171], v9 offset:6144
    v_mfma_f32_16x16x32_bf16 v[88:91], v[64:67], a[248:251], v[88:91]
    ds_read_b128 v[172:175], v9 offset:8192
    v_bfe_u32 v125, s57, v130, 4
    v_mfma_f32_16x16x32_bf16 v[108:111], v[68:71], a[248:251], v[108:111]
    s_add_u32 m0, s41, 74624
    v_cmp_gt_u32 s[30:31], 8, v129
    v_mad_u32_u24 v124, v125, s53, v124
    v_mfma_f32_16x16x32_bf16 v[92:95], v[64:67], a[252:255], v[92:95]
    buffer_load_dwordx4 v5, s[8:11], s80 offen offset:1152 lds
    v_cndmask_b32 v43, v126, v123, s[0:1]
    v_mfma_f32_16x16x32_bf16 v[112:115], v[68:71], a[252:255], v[112:115]
    v_cndmask_b32 v148, v126, v124, s[30:31]
    v_mfma_f32_16x16x32_bf16 v[96:99], v[64:67], v[152:155], v[96:99]
    v_mfma_f32_16x16x32_bf16 v[116:119], v[68:71], v[152:155], v[116:119]
    s_add_u32 m0, s41, 104192
    s_waitcnt vmcnt(6) lgkmcnt(0)
    s_barrier
    buffer_load_dwordx4 v4, s[8:11], s72 offen offset:2304 lds
    v_mfma_f32_16x16x32_bf16 v[80:83], v[72:75], v[156:159], v[80:83]
    s_add_u32 m0, s41, 108288
    ds_read_b64_tr_b16 v[64:65], v10 offset:26624
    ds_read_b64_tr_b16 v[66:67], v10 offset:27136
    v_mfma_f32_16x16x32_bf16 v[100:103], v[76:79], v[156:159], v[100:103]
    buffer_load_dwordx4 v5, s[8:11], s72 offen offset:2304 lds
    ds_read_b128 v[176:179], v8 offset:26624
    v_mfma_f32_16x16x32_bf16 v[84:87], v[72:75], v[160:163], v[84:87]
    ds_read_b64_tr_b16 v[68:69], v11 offset:26624
    ds_read_b64_tr_b16 v[70:71], v11 offset:27136
    v_mfma_f32_16x16x32_bf16 v[104:107], v[76:79], v[160:163], v[104:107]
    s_add_u32 m0, s41, 112384
    ds_read_b128 v[180:183], v8 offset:28672
    v_mfma_f32_16x16x32_bf16 v[88:91], v[72:75], v[164:167], v[88:91]
    buffer_load_dwordx4 v4, s[8:11], s73 offen offset:2304 lds
    ds_read_b128 v[184:187], v8 offset:30720
    v_mfma_f32_16x16x32_bf16 v[108:111], v[76:79], v[164:167], v[108:111]
    ds_read_b128 v[188:191], v8 offset:32768
    v_mfma_f32_16x16x32_bf16 v[92:95], v[72:75], v[168:171], v[92:95]
    s_add_u32 m0, s41, 116480
    ds_read_b128 v[192:195], v8 offset:34816
    v_mfma_f32_16x16x32_bf16 v[112:115], v[76:79], v[168:171], v[112:115]
    buffer_load_dwordx4 v5, s[8:11], s73 offen offset:2304 lds
    ds_read_b128 v[196:199], v9 offset:26624
    v_mfma_f32_16x16x32_bf16 v[96:99], v[72:75], v[172:175], v[96:99]
    ds_read_b128 v[200:203], v9 offset:28672
    v_mfma_f32_16x16x32_bf16 v[116:119], v[76:79], v[172:175], v[116:119]
    s_add_u32 m0, s41, 120576
    ds_read_b128 v[204:207], v9 offset:30720
    s_waitcnt lgkmcnt(3)
    v_mfma_f32_16x16x32_bf16 v[80:83], v[64:67], v[176:179], v[80:83]
    buffer_load_dwordx4 v4, s[8:11], s74 offen offset:2304 lds
    v_mfma_f32_16x16x32_bf16 v[100:103], v[68:71], v[176:179], v[100:103]
    ds_read_b64_tr_b16 v[72:73], v10 offset:30720
    ds_read_b64_tr_b16 v[74:75], v10 offset:31232
    v_mfma_f32_16x16x32_bf16 v[84:87], v[64:67], v[180:183], v[84:87]
    s_add_u32 m0, s41, 124672
    ds_read_b64_tr_b16 v[76:77], v11 offset:30720
    ds_read_b64_tr_b16 v[78:79], v11 offset:31232
    v_mfma_f32_16x16x32_bf16 v[104:107], v[68:71], v[180:183], v[104:107]
    buffer_load_dwordx4 v5, s[8:11], s74 offen offset:2304 lds
    ds_read_b128 v[208:211], v9 offset:32768
    v_mfma_f32_16x16x32_bf16 v[88:91], v[64:67], v[184:187], v[88:91]
    ds_read_b128 v[212:215], v9 offset:34816
    v_mfma_f32_16x16x32_bf16 v[108:111], v[68:71], v[184:187], v[108:111]
    s_add_u32 m0, s41, 128768
    v_cmp_eq_u32 vcc, 0, v63
    v_mfma_f32_16x16x32_bf16 v[92:95], v[64:67], v[188:191], v[92:95]
    buffer_load_dwordx4 v4, s[8:11], s75 offen offset:2304 lds
    v_mfma_f32_16x16x32_bf16 v[112:115], v[68:71], v[188:191], v[112:115]
    v_mfma_f32_16x16x32_bf16 v[96:99], v[64:67], v[192:195], v[96:99]
    s_cbranch_vccnz L_go_retry
L_go_ok:
    v_mfma_f32_16x16x32_bf16 v[116:119], v[68:71], v[192:195], v[116:119]
    v_readfirstlane_b32 s45, v63
    v_cndmask_b32 v62, 0, v63, s[24:25]
    s_waitcnt vmcnt(7) lgkmcnt(0)
    s_barrier
    s_mov_b64 exec, 0x1fffff
    buffer_load_dword v1, v149, s[12:15], 0 offen
    s_mov_b64 exec, -1
    v_mfma_f32_16x16x32_bf16 v[80:83], v[72:75], v[196:199], v[80:83]
    ds_read_b64_tr_b16 v[64:65], v10 offset:53248
    ds_read_b64_tr_b16 v[66:67], v10 offset:53760
    v_mfma_f32_16x16x32_bf16 v[100:103], v[76:79], v[196:199], v[100:103]
    ds_read_b128 v[216:219], v8 offset:53248
    v_mfma_f32_16x16x32_bf16 v[84:87], v[72:75], v[200:203], v[84:87]
    ds_read_b64_tr_b16 v[68:69], v11 offset:53248
    ds_read_b64_tr_b16 v[70:71], v11 offset:53760
    v_mfma_f32_16x16x32_bf16 v[104:107], v[76:79], v[200:203], v[104:107]
    ds_read_b128 v[236:239], v9 offset:53248
    v_mfma_f32_16x16x32_bf16 v[88:91], v[72:75], v[204:207], v[88:91]
    ds_read_b64_tr_b16 v[144:145], v11 offset:57344
    ds_read_b64_tr_b16 v[146:147], v11 offset:57856
    v_mfma_f32_16x16x32_bf16 v[108:111], v[76:79], v[204:207], v[108:111]
    ds_read_b64_tr_b16 v[140:141], v10 offset:57344
    ds_read_b64_tr_b16 v[142:143], v10 offset:57856
    v_mfma_f32_16x16x32_bf16 v[92:95], v[72:75], v[208:211], v[92:95]
    s_add_u32 m0, s41, 132864
    ds_read_b128 v[220:223], v8 offset:55296
    v_mfma_f32_16x16x32_bf16 v[112:115], v[76:79], v[208:211], v[112:115]
    buffer_load_dwordx4 v5, s[8:11], s75 offen offset:2304 lds
    ds_read_b128 v[240:243], v9 offset:55296
    v_mfma_f32_16x16x32_bf16 v[96:99], v[72:75], v[212:215], v[96:99]
    ds_read_b128 v[224:227], v8 offset:57344
    v_mfma_f32_16x16x32_bf16 v[116:119], v[76:79], v[212:215], v[116:119]
    s_waitcnt lgkmcnt(3)
    ds_read_b128 v[244:247], v9 offset:57344
    v_mfma_f32_16x16x32_bf16 v[80:83], v[64:67], v[216:219], v[80:83]
    ds_read_b128 v[228:231], v8 offset:59392
    v_mfma_f32_16x16x32_bf16 v[100:103], v[68:71], v[216:219], v[100:103]
    ds_read_b128 v[248:251], v9 offset:59392
    v_mfma_f32_16x16x32_bf16 v[100:103], v[144:147], v[236:239], v[100:103]
    ds_read_b128 v[232:235], v8 offset:61440
    v_mfma_f32_16x16x32_bf16 v[80:83], v[140:143], v[236:239], v[80:83]
    s_waitcnt lgkmcnt(5)
    ds_read_b128 v[252:255], v9 offset:61440
    v_mfma_f32_16x16x32_bf16 v[84:87], v[64:67], v[220:223], v[84:87]
    v_mfma_f32_16x16x32_bf16 v[104:107], v[68:71], v[220:223], v[104:107]
    v_mfma_f32_16x16x32_bf16 v[104:107], v[144:147], v[240:243], v[104:107]
    s_nop 0
    v_cvt_pk_bf16_f32 v120, v100, v101
    v_cvt_pk_bf16_f32 v121, v102, v103
    v_mfma_f32_16x16x32_bf16 v[84:87], v[140:143], v[240:243], v[84:87]
    s_waitcnt lgkmcnt(4)
    ds_write_b64 v15, v[120:121] offset:0
    v_cvt_pk_bf16_f32 v122, v80, v81
    v_mfma_f32_16x16x32_bf16 v[88:91], v[64:67], v[224:227], v[88:91]
    ds_write_b32 v13, v122 offset:0
    v_cvt_pk_bf16_f32 v123, v82, v83
    v_mfma_f32_16x16x32_bf16 v[108:111], v[68:71], v[224:227], v[108:111]
    ds_write_b32 v14, v123 offset:0
    v_mfma_f32_16x16x32_bf16 v[108:111], v[144:147], v[244:247], v[108:111]
    v_cvt_pk_bf16_f32 v124, v104, v105
    v_cvt_pk_bf16_f32 v125, v106, v107
    v_mfma_f32_16x16x32_bf16 v[88:91], v[140:143], v[244:247], v[88:91]
    s_waitcnt lgkmcnt(5)
    ds_write_b64 v15, v[124:125] offset:512
    v_cvt_pk_bf16_f32 v126, v84, v85
    v_mfma_f32_16x16x32_bf16 v[92:95], v[64:67], v[228:231], v[92:95]
    ds_write_b32 v13, v126 offset:512
    v_cvt_pk_bf16_f32 v127, v86, v87
    v_mfma_f32_16x16x32_bf16 v[112:115], v[68:71], v[228:231], v[112:115]
    ds_write_b32 v14, v127 offset:512
    v_mfma_f32_16x16x32_bf16 v[112:115], v[144:147], v[248:251], v[112:115]
    v_cvt_pk_bf16_f32 v128, v108, v109
    v_cvt_pk_bf16_f32 v129, v110, v111
    v_mfma_f32_16x16x32_bf16 v[92:95], v[140:143], v[248:251], v[92:95]
    s_waitcnt lgkmcnt(6)
    ds_write_b64 v15, v[128:129] offset:1024
    v_cvt_pk_bf16_f32 v130, v88, v89
    v_mfma_f32_16x16x32_bf16 v[96:99], v[64:67], v[232:235], v[96:99]
    s_add_u32 m0, s41, 136960
    ds_write_b32 v13, v130 offset:1024
    v_cvt_pk_bf16_f32 v131, v90, v91
    v_mfma_f32_16x16x32_bf16 v[116:119], v[68:71], v[232:235], v[116:119]
    buffer_load_dwordx4 v4, s[8:11], s76 offen offset:2304 lds
    ds_write_b32 v14, v131 offset:1024
    v_mfma_f32_16x16x32_bf16 v[116:119], v[144:147], v[252:255], v[116:119]
    v_cvt_pk_bf16_f32 v132, v112, v113
    v_cvt_pk_bf16_f32 v133, v114, v115
    v_mfma_f32_16x16x32_bf16 v[96:99], v[140:143], v[252:255], v[96:99]
    ds_write_b64 v15, v[132:133] offset:1536
    v_cvt_pk_bf16_f32 v134, v92, v93
    ds_write_b32 v13, v134 offset:1536
    v_cvt_pk_bf16_f32 v135, v94, v95
    ds_write_b32 v14, v135 offset:1536
    v_cvt_pk_bf16_f32 v136, v116, v117
    v_cvt_pk_bf16_f32 v137, v118, v119
    s_nop 0
    v_cvt_pk_bf16_f32 v138, v96, v97
    v_cvt_pk_bf16_f32 v139, v98, v99
    ds_write_b64 v15, v[136:137] offset:2048
    ds_write_b32 v13, v138 offset:2048
    ds_write_b32 v14, v139 offset:2048
    s_add_u32 m0, s41, 141056
    s_nop 0
    buffer_load_dwordx4 v5, s[8:11], s76 offen offset:2304 lds
    s_waitcnt lgkmcnt(0)
    s_barrier
    ds_read_b64 v[96:97], v16 offset:0
    ds_read_b64 v[98:99], v17 offset:0
    ds_read_b64 v[100:101], v18 offset:0
    ds_read_b64 v[102:103], v19 offset:0
    ds_read_b64 v[104:105], v16 offset:7680
    ds_read_b64 v[106:107], v17 offset:7680
    ds_read_b64 v[108:109], v18 offset:18032
    ds_read_b64 v[110:111], v19 offset:18032
    ds_read_b64 v[112:113], v24 offset:0
    ds_read_b64 v[114:115], v25 offset:0
    s_waitcnt lgkmcnt(6)
    v_mfma_f32_16x16x32_bf16 v[64:67], v[96:99], v[100:103], v[48:51]
    ds_read_b64 v[116:117], v26 offset:0
    ds_read_b64 v[118:119], v27 offset:0
    ds_read_b64 v[128:129], v16 offset:0
    ds_read_b64 v[130:131], v16 offset:2560
    s_waitcnt lgkmcnt(6)
    v_mfma_f32_16x16x32_bf16 v[68:71], v[104:107], v[108:111], v[48:51]
    ds_read_b64 v[132:133], v16 offset:5120
    ds_read_b64 v[134:135], v16 offset:7680
    ds_read_b64 v[136:137], v18 offset:2576
    ds_read_b64 v[138:139], v18 offset:5152
    s_waitcnt lgkmcnt(6)
    v_mfma_f32_16x16x32_bf16 v[72:75], v[112:115], v[116:119], 0
    ds_read_b64 v[140:141], v18 offset:7728
    ds_read_b64 v[142:143], v18 offset:10304
    s_add_u32 m0, s41, 145152
    ds_read_b64 v[144:145], v18 offset:12880
    buffer_load_dwordx4 v4, s[8:11], s77 offen offset:2304 lds
    ds_read_b64 v[146:147], v18 offset:15456
    v_permlane32_swap_b32 v64, v68
    v_permlane32_swap_b32 v65, v69
    v_permlane32_swap_b32 v66, v70
    v_permlane32_swap_b32 v67, v71
    v_permlane32_swap_b32 v72, v76
    v_permlane32_swap_b32 v73, v77
    v_permlane32_swap_b32 v74, v78
    s_add_u32 m0, s41, 149248
    v_permlane32_swap_b32 v75, v79
    buffer_load_dwordx4 v5, s[8:11], s77 offen offset:2304 lds
    v_cndmask_b32 v64, v68, v64, s[60:61]
    v_cndmask_b32 v65, v69, v65, s[62:63]
    v_cndmask_b32 v66, v70, v66, s[64:65]
    v_cndmask_b32 v67, v71, v67, s[66:67]
    v_cndmask_b32 v72, v76, v72, s[60:61]
    v_cndmask_b32 v73, v77, v73, s[62:63]
    v_cndmask_b32 v74, v78, v74, s[64:65]
    s_add_u32 m0, s41, 153344
    v_cndmask_b32 v75, v79, v75, s[66:67]
    buffer_load_dwordx4 v4, s[8:11], s78 offen offset:2304 lds
    v_permlane16_swap_b32 v64, v72
    v_permlane16_swap_b32 v65, v73
    v_permlane16_swap_b32 v66, v74
    v_permlane16_swap_b32 v67, v75
    v_cvt_pk_bf16_f32 v76, v64, v65
    v_cvt_pk_bf16_f32 v77, v66, v67
    v_cvt_pk_bf16_f32 v78, v72, v73
    v_cvt_pk_bf16_f32 v79, v74, v75
    v_add3_u32 v68, v76, v77, s45
    v_add3_u32 v68, v68, v78, v79
    buffer_store_dwordx4 v[76:79], v35, s[20:23], 0 offen sc1
    buffer_store_dword v68, v60, s[20:23], 0 offen offset:256 sc1
    s_waitcnt vmcnt(10) lgkmcnt(0)
    v_mfma_f32_16x16x32_bf16 v[80:83], v[128:131], v[136:139], v[48:51]
    s_barrier
    ds_read_b64_tr_b16 v[116:117], v12 offset:0
    ds_read_b64_tr_b16 v[118:119], v12 offset:512
    v_mfma_f32_16x16x32_bf16 v[84:87], v[130:133], v[140:143], v[48:51]
    ds_read_b64_tr_b16 v[120:121], v12 offset:4096
    ds_read_b64_tr_b16 v[122:123], v12 offset:4608
    v_mfma_f32_16x16x32_bf16 v[88:91], v[132:135], v[144:147], v[48:51]
    ds_write_b64 v34, v[150:151]
    s_waitcnt lgkmcnt(3)
    v_mfma_f32_16x16x32_bf16 v[96:99], a[0:3], v[116:119], 0
    ds_read_b64_tr_b16 v[124:125], v12 offset:8192
    ds_read_b64 a[0:1], v17 offset:0
    v_mfma_f32_16x16x32_bf16 v[100:103], a[4:7], v[116:119], 0
    s_add_u32 m0, s41, 157440
    ds_read_b64_tr_b16 v[126:127], v12 offset:8704
    ds_read_b64 a[2:3], v17 offset:2560
    v_mfma_f32_16x16x32_bf16 v[104:107], a[8:11], v[116:119], 0
    buffer_load_dwordx4 v5, s[8:11], s78 offen offset:2304 lds
    ds_read_b64 a[4:5], v17 offset:5120
    v_mfma_f32_16x16x32_bf16 v[108:111], a[12:15], v[116:119], 0
    s_add_u32 m0, s41, 7936
    ds_read_b64 a[6:7], v17 offset:7680
    ds_read_b64 a[8:9], v19 offset:2576
    v_mfma_f32_16x16x32_bf16 v[112:115], a[16:19], v[116:119], 0
    s_waitcnt lgkmcnt(8)
    buffer_load_dwordx4 v4, s[8:11], s79 offen offset:2304 lds
    ds_read_b64 a[10:11], v19 offset:5152
    v_mfma_f32_16x16x32_bf16 v[96:99], a[20:23], v[120:123], v[96:99]
    ds_read_b64_tr_b16 v[116:117], v12 offset:12288
    ds_read_b64 a[12:13], v19 offset:7728
    v_mfma_f32_16x16x32_bf16 v[100:103], a[24:27], v[120:123], v[100:103]
    s_add_u32 m0, s41, 12032
    ds_read_b64_tr_b16 v[118:119], v12 offset:12800
    ds_read_b64 a[14:15], v19 offset:10304
    v_mfma_f32_16x16x32_bf16 v[104:107], a[28:31], v[120:123], v[104:107]
    buffer_load_dwordx4 v5, s[8:11], s79 offen offset:2304 lds
    ds_read_b64 a[16:17], v19 offset:12880
    v_mfma_f32_16x16x32_bf16 v[108:111], a[32:35], v[120:123], v[108:111]
    s_add_u32 m0, s41, 16128
    ds_read_b64 a[18:19], v19 offset:15456
    ds_read_b64 a[20:21], v20 offset:0
    v_mfma_f32_16x16x32_bf16 v[112:115], a[36:39], v[120:123], v[112:115]
    s_waitcnt lgkmcnt(12)
    buffer_load_dwordx4 v4, s[8:11], s80 offen offset:2304 lds
    ds_read_b64 a[22:23], v20 offset:2560
    v_mfma_f32_16x16x32_bf16 v[96:99], a[40:43], v[124:127], v[96:99]
    ds_read_b64_tr_b16 v[120:121], v12 offset:16384
    ds_read_b64 a[24:25], v22 offset:0
    v_mfma_f32_16x16x32_bf16 v[100:103], a[44:47], v[124:127], v[100:103]
    s_add_u32 m0, s41, 20224
    ds_read_b64_tr_b16 v[122:123], v12 offset:16896
    ds_read_b64 a[26:27], v22 offset:2576
    v_mfma_f32_16x16x32_bf16 v[104:107], a[48:51], v[124:127], v[104:107]
    buffer_load_dwordx4 v5, s[8:11], s80 offen offset:2304 lds
    s_waitcnt lgkmcnt(6)
    v_mfma_f32_16x16x32_bf16 v[80:83], a[0:3], a[8:11], v[80:83]
    ds_read_b64 a[28:29], v21 offset:0
    ds_read_b64 a[30:31], v21 offset:2560
    v_mfma_f32_16x16x32_bf16 v[84:87], a[2:5], a[12:15], v[84:87]
    ds_read_b64 a[32:33], v23 offset:0
    ds_read_b64 a[34:35], v23 offset:2576
    v_mfma_f32_16x16x32_bf16 v[88:91], a[4:7], a[16:19], v[88:91]
    v_mfma_f32_16x16x32_bf16 v[108:111], a[52:55], v[124:127], v[108:111]
    v_mfma_f32_16x16x32_bf16 v[112:115], a[56:59], v[124:127], v[112:115]
    s_waitcnt lgkmcnt(0)
    v_mfma_f32_16x16x32_bf16 v[92:95], a[20:23], a[24:27], 0
    v_mfma_f32_16x16x32_bf16 v[92:95], a[28:31], a[32:35], v[92:95]
    v_permlane32_swap_b32 v80, v84
    v_mfma_f32_16x16x32_bf16 v[96:99], a[60:63], v[116:119], v[96:99]
    s_mul_i32 s46, s42, 73728
    ds_read_b64_tr_b16 v[124:125], v12 offset:20480
    v_permlane32_swap_b32 v81, v85
    v_mfma_f32_16x16x32_bf16 v[100:103], a[64:67], v[116:119], v[100:103]
    s_add_u32 m0, s41, 53248
    ds_read_b64_tr_b16 v[126:127], v12 offset:20992
    v_permlane32_swap_b32 v82, v86
    v_mfma_f32_16x16x32_bf16 v[104:107], a[68:71], v[116:119], v[104:107]
    buffer_load_dwordx4 v6, s[12:15], s46 offen lds
    v_permlane32_swap_b32 v83, v87
    v_mfma_f32_16x16x32_bf16 v[108:111], a[72:75], v[116:119], v[108:111]
    v_permlane32_swap_b32 v88, v92
    v_mfma_f32_16x16x32_bf16 v[112:115], a[76:79], v[116:119], v[112:115]
    v_permlane32_swap_b32 v89, v93
    v_permlane32_swap_b32 v90, v94
    v_mfma_f32_16x16x32_bf16 v[96:99], a[80:83], v[120:123], v[96:99]
    s_waitcnt vmcnt(9) lgkmcnt(0)
    s_barrier
    v_mfma_f32_16x16x32_bf16 v[100:103], a[84:87], v[120:123], v[100:103]
    s_add_u32 m0, s41, 57344
    ds_read_b64_tr_b16 v[116:117], v12 offset:24576
    v_permlane32_swap_b32 v91, v95
    v_mfma_f32_16x16x32_bf16 v[104:107], a[88:91], v[120:123], v[104:107]
    buffer_load_dwordx4 v7, s[12:15], s46 offen lds
    v_cndmask_b32 v80, v84, v80, s[60:61]
    v_cndmask_b32 v81, v85, v81, s[62:63]
    v_mfma_f32_16x16x32_bf16 v[108:111], a[92:95], v[120:123], v[108:111]
    ds_read_b64_tr_b16 v[118:119], v12 offset:25088
    v_cndmask_b32 v82, v86, v82, s[64:65]
    v_mfma_f32_16x16x32_bf16 v[112:115], a[96:99], v[120:123], v[112:115]
    s_bfe_u32 s29, s28, 262144
    v_cndmask_b32 v83, v87, v83, s[66:67]
    v_mfma_f32_16x16x32_bf16 v[96:99], a[100:103], v[124:127], v[96:99]
    s_mul_i32 s46, s29, 73728
    ds_read_b64_tr_b16 v[120:121], v12 offset:28672
    v_cndmask_b32 v88, v92, v88, s[60:61]
    v_mfma_f32_16x16x32_bf16 v[100:103], a[104:107], v[124:127], v[100:103]
    s_add_u32 m0, s41, 61440
    ds_read_b64_tr_b16 v[122:123], v12 offset:29184
    v_cndmask_b32 v89, v93, v89, s[62:63]
    v_cndmask_b32 v90, v94, v90, s[64:65]
    v_mfma_f32_16x16x32_bf16 v[104:107], a[108:111], v[124:127], v[104:107]
    buffer_load_dwordx4 v6, s[12:15], s46 offen lds
    s_mul_i32 s73, s29, 10496
    v_mfma_f32_16x16x32_bf16 v[108:111], a[112:115], v[124:127], v[108:111]
    s_add_u32 m0, s41, 65536
    v_cndmask_b32 v91, v95, v91, s[66:67]
    v_permlane16_swap_b32 v80, v88
    v_mfma_f32_16x16x32_bf16 v[112:115], a[116:119], v[124:127], v[112:115]
    s_waitcnt lgkmcnt(2)
    buffer_load_dwordx4 v7, s[12:15], s46 offen lds
    s_bfe_u32 s29, s28, 262148
    v_permlane16_swap_b32 v81, v89
    v_mfma_f32_16x16x32_bf16 v[96:99], a[120:123], v[116:119], v[96:99]
    s_mul_i32 s46, s29, 73728
    ds_read_b64_tr_b16 v[124:125], v12 offset:32768
    v_permlane16_swap_b32 v82, v90
    v_mfma_f32_16x16x32_bf16 v[100:103], a[124:127], v[116:119], v[100:103]
    s_add_u32 m0, s41, 69632
    ds_read_b64_tr_b16 v[126:127], v12 offset:33280
    v_permlane16_swap_b32 v83, v91
    v_mfma_f32_16x16x32_bf16 v[104:107], a[128:131], v[116:119], v[104:107]
    buffer_load_dwordx4 v6, s[12:15], s46 offen lds
    v_max3_f32 v140, v80, v81, v82
    v_mfma_f32_16x16x32_bf16 v[108:111], a[132:135], v[116:119], v[108:111]
    v_max3_f32 v140, v140, v83, v88
    v_max3_f32 v140, v140, v89, v90
    v_max_f32 v140, v140, v91
    v_mfma_f32_16x16x32_bf16 v[112:115], a[136:139], v[116:119], v[112:115]
    s_waitcnt lgkmcnt(2)
    v_mul_f32 v140, s68, v140
    v_fma_f32 v80, v80, s68, -v140
    v_mfma_f32_16x16x32_bf16 v[96:99], a[140:143], v[120:123], v[96:99]
    s_mul_i32 s74, s29, 10496
    ds_read_b64_tr_b16 v[116:117], v12 offset:36864
    v_fma_f32 v81, v81, s68, -v140
    v_mfma_f32_16x16x32_bf16 v[100:103], a[144:147], v[120:123], v[100:103]
    s_bfe_u32 s29, s28, 262152
    s_add_u32 m0, s41, 73728
    ds_read_b64_tr_b16 v[118:119], v12 offset:37376
    v_mfma_f32_16x16x32_bf16 v[104:107], a[148:151], v[120:123], v[104:107]
    buffer_load_dwordx4 v7, s[12:15], s46 offen lds
    s_mul_i32 s46, s29, 73728
    v_exp_f32 v80, v80
    v_mfma_f32_16x16x32_bf16 v[108:111], a[152:155], v[120:123], v[108:111]
    s_add_u32 m0, s41, 79872
    v_fma_f32 v82, v82, s68, -v140
    v_exp_f32 v81, v81
    v_mfma_f32_16x16x32_bf16 v[112:115], a[156:159], v[120:123], v[112:115]
    s_waitcnt lgkmcnt(2)
    buffer_load_dwordx4 v6, s[12:15], s46 offen lds
    v_exp_f32 v82, v82
    v_mfma_f32_16x16x32_bf16 v[96:99], a[160:163], v[124:127], v[96:99]
    s_mul_i32 s75, s29, 10496
    ds_read_b64_tr_b16 v[120:121], v12 offset:40960
    v_fma_f32 v83, v83, s68, -v140
    v_mfma_f32_16x16x32_bf16 v[100:103], a[164:167], v[124:127], v[100:103]
    s_bfe_u32 s29, s28, 262156
    s_add_u32 m0, s41, 83968
    ds_read_b64_tr_b16 v[122:123], v12 offset:41472
    v_fma_f32 v88, v88, s68, -v140
    v_mfma_f32_16x16x32_bf16 v[104:107], a[168:171], v[124:127], v[104:107]
    buffer_load_dwordx4 v7, s[12:15], s46 offen lds
    s_mul_i32 s46, s29, 73728
    v_mfma_f32_16x16x32_bf16 v[108:111], a[172:175], v[124:127], v[108:111]
    s_add_u32 m0, s41, 88064
    v_fma_f32 v89, v89, s68, -v140
    v_exp_f32 v83, v83
    v_mfma_f32_16x16x32_bf16 v[112:115], a[176:179], v[124:127], v[112:115]
    s_waitcnt lgkmcnt(2)
    buffer_load_dwordx4 v6, s[12:15], s46 offen lds
    v_exp_f32 v88, v88
    v_mfma_f32_16x16x32_bf16 v[96:99], a[180:183], v[116:119], v[96:99]
    s_mul_i32 s76, s29, 10496
    ds_read_b64_tr_b16 v[124:125], v12 offset:45056
    v_exp_f32 v89, v89
    v_mfma_f32_16x16x32_bf16 v[100:103], a[184:187], v[116:119], v[100:103]
    s_add_u32 m0, s41, 92160
    ds_read_b64_tr_b16 v[126:127], v12 offset:45568
    v_fma_f32 v90, v90, s68, -v140
    v_mfma_f32_16x16x32_bf16 v[104:107], a[188:191], v[116:119], v[104:107]
    buffer_load_dwordx4 v7, s[12:15], s46 offen lds
    v_fma_f32 v91, v91, s68, -v140
    v_mfma_f32_16x16x32_bf16 v[108:111], a[192:195], v[116:119], v[108:111]
    v_add_f32 v141, v80, v81
    v_exp_f32 v90, v90
    v_mfma_f32_16x16x32_bf16 v[112:115], a[196:199], v[116:119], v[112:115]
    s_bfe_u32 s29, s28, 262160
    s_waitcnt lgkmcnt(2)
    v_exp_f32 v91, v91
    v_mfma_f32_16x16x32_bf16 v[96:99], a[200:203], v[120:123], v[96:99]
    s_mul_i32 s46, s29, 73728
    s_waitcnt vmcnt(10) lgkmcnt(0)
    s_barrier
    v_add_f32 v141, v141, v82
    v_mfma_f32_16x16x32_bf16 v[100:103], a[204:207], v[120:123], v[100:103]
    s_add_u32 m0, s41, 96256
    ds_read_b64_tr_b16 v[116:117], v12 offset:49152
    v_add_f32 v141, v141, v83
    v_mfma_f32_16x16x32_bf16 v[104:107], a[208:211], v[120:123], v[104:107]
    buffer_load_dwordx4 v6, s[12:15], s46 offen lds
    v_add_f32 v141, v141, v88
    v_mfma_f32_16x16x32_bf16 v[108:111], a[212:215], v[120:123], v[108:111]
    ds_read_b64_tr_b16 v[118:119], v12 offset:49664
    v_add_f32 v141, v141, v89
    v_mfma_f32_16x16x32_bf16 v[112:115], a[216:219], v[120:123], v[112:115]
    buffer_load_dwordx4 v[68:71], v36, s[20:23], 0 offen sc1
    buffer_load_dword v76, v61, s[20:23], 0 offen offset:256 sc1
    v_add_f32 v141, v141, v90
    v_mfma_f32_16x16x32_bf16 v[96:99], a[220:223], v[124:127], v[96:99]
    s_mul_i32 s77, s29, 10496
    ds_read_b64_tr_b16 v[120:121], v12 offset:53248
    v_add_f32 v141, v141, v91
    v_mfma_f32_16x16x32_bf16 v[100:103], a[224:227], v[124:127], v[100:103]
    s_add_u32 m0, s41, 100352
    ds_read_b64_tr_b16 v[122:123], v12 offset:53760
    v_rcp_f32 v140, v141
    v_mfma_f32_16x16x32_bf16 v[104:107], a[228:231], v[124:127], v[104:107]
    buffer_load_dwordx4 v7, s[12:15], s46 offen lds
    v_mul_f32 v80, v80, v140
    v_mfma_f32_16x16x32_bf16 v[108:111], a[232:235], v[124:127], v[108:111]
    v_mul_f32 v81, v81, v140
    v_mul_f32 v82, v82, v140
    v_mul_f32 v83, v83, v140
    v_mfma_f32_16x16x32_bf16 v[112:115], a[236:239], v[124:127], v[112:115]
    s_bfe_u32 s29, s28, 262164
    s_waitcnt lgkmcnt(2)
    v_mul_f32 v88, v88, v140
    v_mfma_f32_16x16x32_bf16 v[96:99], a[240:243], v[116:119], v[96:99]
    s_mul_i32 s46, s29, 73728
    ds_read_b64_tr_b16 v[124:125], v10 offset:0
    v_mul_f32 v89, v89, v140
    v_mfma_f32_16x16x32_bf16 v[100:103], a[244:247], v[116:119], v[100:103]
    s_add_u32 m0, s41, 106496
    ds_read_b64_tr_b16 v[126:127], v10 offset:512
    v_mul_f32 v90, v90, v140
    v_mfma_f32_16x16x32_bf16 v[104:107], a[248:251], v[116:119], v[104:107]
    buffer_load_dwordx4 v6, s[12:15], s46 offen lds
    v_mul_f32 v91, v91, v140
    v_cvt_pk_bf16_f32 v84, v80, v81
    v_mfma_f32_16x16x32_bf16 v[108:111], a[252:255], v[116:119], v[108:111]
    v_cvt_pk_bf16_f32 v85, v82, v83
    v_cvt_pk_bf16_f32 v86, v88, v89
    v_mfma_f32_16x16x32_bf16 v[112:115], v[152:155], v[116:119], v[112:115]
    s_waitcnt lgkmcnt(2)
    v_cvt_pk_bf16_f32 v87, v90, v91
    v_and_b32 v92, v84, v44
    v_mfma_f32_16x16x32_bf16 v[96:99], v[156:159], v[120:123], v[96:99]
    s_mul_i32 s78, s29, 10496
    ds_read_b64_tr_b16 v[116:117], v10 offset:4096
    v_and_b32 v93, v85, v45
    v_mfma_f32_16x16x32_bf16 v[100:103], v[160:163], v[120:123], v[100:103]
    s_add_u32 m0, s41, 110592
    ds_read_b64_tr_b16 v[118:119], v10 offset:4608
    v_and_b32 v94, v86, v46
    v_and_b32 v95, v87, v47
    v_mfma_f32_16x16x32_bf16 v[104:107], v[164:167], v[120:123], v[104:107]
    buffer_load_dwordx4 v7, s[12:15], s46 offen lds
    ds_write_b128 v29, v[92:95]
    v_mfma_f32_16x16x32_bf16 v[108:111], v[168:171], v[120:123], v[108:111]
    v_xor_b32 v84, v84, v92
    v_xor_b32 v85, v85, v93
    v_mfma_f32_16x16x32_bf16 v[112:115], v[172:175], v[120:123], v[112:115]
    s_bfe_u32 s29, s28, 262168
    s_waitcnt lgkmcnt(3)
    v_xor_b32 v86, v86, v94
    v_mfma_f32_16x16x32_bf16 v[96:99], v[176:179], v[124:127], v[96:99]
    s_mul_i32 s46, s29, 73728
    ds_read_b64_tr_b16 v[120:121], v11 offset:0
    v_xor_b32 v87, v87, v95
    v_mfma_f32_16x16x32_bf16 v[100:103], v[180:183], v[124:127], v[100:103]
    s_add_u32 m0, s41, 114688
    ds_read_b64_tr_b16 v[122:123], v11 offset:512
    ds_write_b128 v29, v[84:87] offset:256
    v_mfma_f32_16x16x32_bf16 v[104:107], v[184:187], v[124:127], v[104:107]
    buffer_load_dwordx4 v6, s[12:15], s46 offen lds
    v_mov_b32 v128, 0
    v_mfma_f32_16x16x32_bf16 v[108:111], v[188:191], v[124:127], v[108:111]
    v_mov_b32 v129, 0
    v_mov_b32 v80, 0
    v_mfma_f32_16x16x32_bf16 v[112:115], v[192:195], v[124:127], v[112:115]
    s_waitcnt lgkmcnt(4)
    v_mov_b32 v81, 0
    v_mfma_f32_16x16x32_bf16 v[96:99], v[196:199], v[116:119], v[96:99]
    s_mul_i32 s79, s29, 10496
    ds_read_b64_tr_b16 v[124:125], v11 offset:4096
    v_mfma_f32_16x16x32_bf16 v[100:103], v[200:203], v[116:119], v[100:103]
    s_add_u32 m0, s41, 118784
    ds_read_b64_tr_b16 v[126:127], v11 offset:4608
    s_waitcnt lgkmcnt(2)
    s_barrier
    v_mfma_f32_16x16x32_bf16 v[104:107], v[204:207], v[116:119], v[104:107]
    buffer_load_dwordx4 v7, s[12:15], s46 offen lds
    ds_read_b64 a[40:41], v31 offset:0
    v_mfma_f32_16x16x32_bf16 v[108:111], v[208:211], v[116:119], v[108:111]
    ds_read_b64 a[42:43], v30 offset:0
    ds_read_b64 a[44:45], v31 offset:528
    v_mfma_f32_16x16x32_bf16 v[112:115], v[212:215], v[116:119], v[112:115]
    s_bfe_u32 s29, s28, 262172
    s_waitcnt lgkmcnt(3)
    ds_read_b64 a[46:47], v30 offset:528
    ds_read_b64 a[48:49], v31 offset:1056
    v_mfma_f32_16x16x32_bf16 v[96:99], v[216:219], v[120:123], v[96:99]
    s_mul_i32 s46, s29, 73728
    ds_read_b64 a[50:51], v30 offset:1056
    ds_read_b64 a[52:53], v31 offset:1584
    v_mfma_f32_16x16x32_bf16 v[96:99], v[236:239], v[124:127], v[96:99]
    s_add_u32 m0, s41, 122880
    ds_read_b64 a[54:55], v30 offset:1584
    ds_read_b64 a[56:57], v31 offset:2112
    v_mfma_f32_16x16x32_bf16 v[100:103], v[220:223], v[120:123], v[100:103]
    buffer_load_dwordx4 v6, s[12:15], s46 offen lds
    ds_read_b64 a[58:59], v30 offset:2112
    v_mfma_f32_16x16x32_bf16 v[100:103], v[240:243], v[124:127], v[100:103]
    v_mfma_f32_16x16x32_bf16 v[104:107], v[224:227], v[120:123], v[104:107]
    v_mfma_f32_16x16x32_bf16 v[104:107], v[244:247], v[124:127], v[104:107]
    v_cvt_pk_bf16_f32 v82, v96, v97
    v_cvt_pk_bf16_f32 v83, v98, v99
    v_mfma_f32_16x16x32_bf16 v[108:111], v[228:231], v[120:123], v[108:111]
    v_cndmask_b32 v130, 0, v82, s[84:85]
    v_cndmask_b32 v131, 0, v83, s[84:85]
    v_mfma_f32_16x16x32_bf16 v[108:111], v[248:251], v[124:127], v[108:111]
    v_cvt_pk_bf16_f32 v84, v100, v101
    v_cvt_pk_bf16_f32 v85, v102, v103
    v_mfma_f32_16x16x32_bf16 v[112:115], v[232:235], v[120:123], v[112:115]
    v_cndmask_b32 v132, 0, v84, s[84:85]
    v_cndmask_b32 v133, 0, v85, s[84:85]
    v_mfma_f32_16x16x32_bf16 v[112:115], v[252:255], v[124:127], v[112:115]
    v_cvt_pk_bf16_f32 v86, v104, v105
    v_cvt_pk_bf16_f32 v87, v106, v107
    s_waitcnt vmcnt(6)
    v_add3_u32 v140, v68, v69, v70
    v_add3_u32 v140, v140, v71, v62
    v_cmp_ne_u32 vcc, v76, v140
    v_cndmask_b32 v134, 0, v86, s[84:85]
    v_cndmask_b32 v135, 0, v87, s[84:85]
    v_cvt_pk_bf16_f32 v88, v108, v109
    v_cvt_pk_bf16_f32 v89, v110, v111
    v_cvt_pk_bf16_f32 v90, v112, v113
    v_cvt_pk_bf16_f32 v91, v114, v115
    s_cbranch_vccnz L_rx_retry
L_rx_ok:
    v_dot2_f32_bf16 v64, v68, s70, v64
    v_dot2_f32_bf16 v65, v68, s71, v65
    v_dot2_f32_bf16 v66, v69, s70, v66
    v_dot2_f32_bf16 v67, v69, s71, v67
    v_dot2_f32_bf16 v72, v70, s70, v72
    v_dot2_f32_bf16 v73, v70, s71, v73
    v_dot2_f32_bf16 v74, v71, s70, v74
    v_dot2_f32_bf16 v75, v71, s71, v75
    s_waitcnt lgkmcnt(0)
    v_max3_f32 v140, v64, v65, v66
    v_max3_f32 v140, v140, v67, v72
    v_max3_f32 v140, v140, v73, v74
    v_max_f32 v140, v140, v75
    v_mul_f32 v140, s68, v140
    v_pk_fma_f32 v[64:65], v[64:65], s[68:69], v[140:141] op_sel_hi:[1,1,0] neg_lo:[0,0,1] neg_hi:[0,0,1]
    v_pk_fma_f32 v[66:67], v[66:67], s[68:69], v[140:141] op_sel_hi:[1,1,0] neg_lo:[0,0,1] neg_hi:[0,0,1]
    v_pk_fma_f32 v[72:73], v[72:73], s[68:69], v[140:141] op_sel_hi:[1,1,0] neg_lo:[0,0,1] neg_hi:[0,0,1]
    v_pk_fma_f32 v[74:75], v[74:75], s[68:69], v[140:141] op_sel_hi:[1,1,0] neg_lo:[0,0,1] neg_hi:[0,0,1]
    v_exp_f32 v64, v64
    v_exp_f32 v65, v65
    v_exp_f32 v66, v66
    v_exp_f32 v67, v67
    v_exp_f32 v72, v72
    v_exp_f32 v73, v73
    v_exp_f32 v74, v74
    v_exp_f32 v75, v75
    v_pk_add_f32 v[140:141], v[64:65], v[66:67]
    v_pk_add_f32 v[142:143], v[72:73], v[74:75]
    v_pk_add_f32 v[140:141], v[140:141], v[142:143]
    v_add_f32 v140, v140, v141
    v_rcp_f32 v140, v140
    s_nop 0
    v_pk_mul_f32 v[64:65], v[64:65], v[140:141] op_sel_hi:[1,0]
    v_pk_mul_f32 v[66:67], v[66:67], v[140:141] op_sel_hi:[1,0]
    v_pk_mul_f32 v[72:73], v[72:73], v[140:141] op_sel_hi:[1,0]
    v_pk_mul_f32 v[74:75], v[74:75], v[140:141] op_sel_hi:[1,0]
    v_cvt_pk_bf16_f32 v68, v64, v65
    v_cvt_pk_bf16_f32 v69, v66, v67
    v_cvt_pk_bf16_f32 v70, v72, v73
    v_cvt_pk_bf16_f32 v71, v74, v75
    v_and_b32 v76, v68, v44
    v_and_b32 v77, v69, v45
    v_and_b32 v78, v70, v46
    v_and_b32 v79, v71, v47
    ds_write_b128 v28, v[76:79]
    v_xor_b32 v68, v68, v76
    v_xor_b32 v69, v69, v77
    v_xor_b32 v70, v70, v78
    v_xor_b32 v71, v71, v79
    ds_write_b128 v28, v[68:71] offset:256
    v_mfma_f32_16x16x32_bf16 v[96:99], v[128:131], a[40:43], 0
    s_mul_i32 s80, s29, 10496
    s_add_u32 m0, s41, 126976
    s_nop 0
    buffer_load_dwordx4 v7, s[12:15], s46 offen lds
    v_cndmask_b32 v136, 0, v88, s[84:85]
    v_cndmask_b32 v137, 0, v89, s[84:85]
    v_mfma_f32_16x16x32_bf16 v[100:103], v[130:133], a[44:47], 0
    v_cndmask_b32 v138, 0, v90, s[84:85]
    v_cndmask_b32 v139, 0, v91, s[84:85]
    v_mfma_f32_16x16x32_bf16 v[104:107], v[132:135], a[48:51], 0
    v_xor_b32 v82, v82, v130
    v_xor_b32 v83, v83, v131
    v_xor_b32 v84, v84, v132
    v_xor_b32 v85, v85, v133
    s_waitcnt vmcnt(4) lgkmcnt(0)
    s_barrier
    ds_read_b64 a[60:61], v33 offset:0
    ds_read_b64 a[62:63], v32 offset:0
    v_mfma_f32_16x16x32_bf16 v[108:111], v[134:137], a[52:55], 0
    ds_read_b64 a[64:65], v33 offset:528
    ds_read_b64 a[66:67], v32 offset:528
    ds_read_b64 a[68:69], v33 offset:1056
    v_mfma_f32_16x16x32_bf16 v[112:115], v[136:139], a[56:59], 0
    ds_read_b64 a[70:71], v32 offset:1056
    ds_read_b64 a[72:73], v33 offset:1584
    ds_read_b64 a[74:75], v32 offset:1584
    s_waitcnt lgkmcnt(6)
    v_mfma_f32_16x16x32_bf16 v[96:99], v[80:83], a[60:63], v[96:99]
    ds_read_b64 a[76:77], v33 offset:2112
    ds_read_b64 a[78:79], v32 offset:2112
    s_waitcnt lgkmcnt(6)
    v_mfma_f32_16x16x32_bf16 v[100:103], v[82:85], a[64:67], v[100:103]
    v_xor_b32 v86, v86, v134
    v_xor_b32 v87, v87, v135
    v_xor_b32 v88, v88, v136
    v_xor_b32 v89, v89, v137
    s_waitcnt lgkmcnt(4)
    v_mfma_f32_16x16x32_bf16 v[104:107], v[84:87], a[68:71], v[104:107]
    v_xor_b32 v90, v90, v138
    v_xor_b32 v91, v91, v139
    s_waitcnt lgkmcnt(2)
    v_mfma_f32_16x16x32_bf16 v[108:111], v[86:89], a[72:75], v[108:111]
    v_cvt_pk_bf16_f32 v152, v96, v97
    v_cvt_pk_bf16_f32 v153, v98, v99
    s_waitcnt lgkmcnt(0)
    v_mfma_f32_16x16x32_bf16 v[112:115], v[88:91], a[76:79], v[112:115]
    v_cvt_pk_bf16_f32 v154, v100, v101
    v_cvt_pk_bf16_f32 v155, v102, v103
    v_cvt_pk_bf16_f32 v156, v104, v105
    v_permlane32_swap_b32 v152, v154
    v_permlane32_swap_b32 v153, v155
    buffer_store_dwordx4 v[152:155], v37, s[20:23], 0 offen sc1
    v_cvt_pk_bf16_f32 v158, v108, v109
    v_cvt_pk_bf16_f32 v157, v106, v107
    v_cvt_pk_bf16_f32 v159, v110, v111
    v_cvt_pk_bf16_f32 v160, v112, v113
    v_permlane32_swap_b32 v156, v158
    v_permlane32_swap_b32 v157, v159
    buffer_store_dwordx4 v[156:159], v37, s[20:23], s51 offen sc1
    v_cvt_pk_bf16_f32 v161, v114, v115
    v_add3_u32 v164, v152, v153, v154
    v_add_u32 v164, v164, v155
    v_permlane32_swap_b32 v160, v162
    v_permlane32_swap_b32 v161, v163
    buffer_store_dwordx4 v[160:163], v38, s[20:23], s52 offen sc1
    v_add3_u32 v165, v156, v157, v158
    v_add_u32 v165, v165, v159
    v_add3_u32 v166, v160, v161, v162
    v_add_u32 v166, v166, v163
    v_add_u32_dpp v164, v164, v164 row_ror:8 row_mask:0xf bank_mask:0xf
    v_add_u32_dpp v165, v165, v165 row_ror:8 row_mask:0xf bank_mask:0xf
    v_add_u32_dpp v166, v166, v166 row_ror:8 row_mask:0xf bank_mask:0xf
    v_add_u32_dpp v164, v164, v164 row_ror:4 row_mask:0xf bank_mask:0xf
    v_add_u32_dpp v165, v165, v165 row_ror:4 row_mask:0xf bank_mask:0xf
    v_add_u32_dpp v166, v166, v166 row_ror:4 row_mask:0xf bank_mask:0xf
    v_add_u32_dpp v164, v164, v164 row_ror:2 row_mask:0xf bank_mask:0xf
    v_add_u32_dpp v165, v165, v165 row_ror:2 row_mask:0xf bank_mask:0xf
    v_add_u32_dpp v166, v166, v166 row_ror:2 row_mask:0xf bank_mask:0xf
    v_add_u32_dpp v164, v164, v164 row_ror:1 row_mask:0xf bank_mask:0xf
    v_add_u32_dpp v165, v165, v165 row_ror:1 row_mask:0xf bank_mask:0xf
    v_add_u32_dpp v166, v166, v166 row_ror:1 row_mask:0xf bank_mask:0xf
    v_xor_b32 v164, s45, v164
    v_xor_b32 v165, s45, v165
    v_xor_b32 v166, s45, v166
    buffer_store_dwordx4 v[164:167], v42, s[20:23], 0 offen sc1
    v_add_u32 v1, 131072, v40
    v_add_u32 v2, 131072, v41
    v_cndmask_b32 v3, 0, v63, s[0:1]
    v_cndmask_b32 v4, 0, v63, s[30:31]
    v_mov_b32 v5, v148
    v_and_b32 v25, 15, v0
    v_bfe_u32 v26, v0, 5, 3
    v_and_b32 v27, 7, v0
    v_xor_b32 v26, v26, v27
    v_lshlrev_b32 v26, 4, v26
    v_lshl_add_u32 v26, v25, 7, v26
    v_bfe_u32 v27, v0, 4, 1
    v_lshl_add_u32 v26, v27, 3, v26
    v_lshl_add_u32 v16, s41, 1, v26
    v_xor_b32 v17, 32, v16
    v_xor_b32 v18, 64, v16
    v_xor_b32 v19, 32, v18
    v_lshrrev_b32 v26, 4, v0
    v_xor_b32 v27, v26, v25
    v_lshlrev_b32 v27, 4, v27
    v_add_u32 v27, 147456, v27
    v_lshl_add_u32 v24, v25, 8, v27
    v_lshl_add_u32 v26, v26, 8, v27
    v_lshl_add_u32 v20, s41, 2, v26
    v_xor_b32 v21, 1088, v20
    v_xor_b32 v22, 2176, v20
    v_xor_b32 v23, 3264, v20
    ds_write_b128 v39, v[152:155] offset:0
    ds_read_b64_tr_b16 a[0:1], v52 offset:0
    ds_read_b64_tr_b16 a[2:3], v52 offset:1024
    ds_read_b64_tr_b16 a[4:5], v53 offset:0
    ds_read_b64_tr_b16 a[6:7], v53 offset:1024
    ds_write_b128 v39, v[156:159] offset:4096
    ds_read_b64_tr_b16 a[8:9], v54 offset:0
    ds_read_b64_tr_b16 a[10:11], v54 offset:1024
    ds_read_b64_tr_b16 a[12:13], v55 offset:0
    ds_read_b64_tr_b16 a[14:15], v55 offset:1024
    ds_write_b128 v39, v[160:163] offset:8192
    ds_read_b64_tr_b16 a[16:17], v52 offset:4096
    ds_read_b64_tr_b16 a[18:19], v52 offset:5120
    ds_read_b64_tr_b16 a[20:21], v53 offset:4096
    ds_read_b64_tr_b16 a[22:23], v53 offset:5120
    ds_read_b64_tr_b16 a[24:25], v54 offset:4096
    ds_read_b64_tr_b16 a[26:27], v54 offset:5120
    ds_read_b64_tr_b16 a[28:29], v55 offset:4096
    ds_read_b64_tr_b16 a[30:31], v55 offset:5120
    ds_read_b64_tr_b16 a[32:33], v52 offset:8192
    ds_read_b64_tr_b16 a[34:35], v52 offset:9216
    ds_read_b64_tr_b16 a[36:37], v53 offset:8192
    ds_read_b64_tr_b16 a[38:39], v53 offset:9216
    ds_read_b64_tr_b16 a[40:41], v54 offset:8192
    ds_read_b64_tr_b16 a[42:43], v54 offset:9216
    ds_read_b64_tr_b16 a[44:45], v55 offset:8192
    ds_read_b64_tr_b16 a[46:47], v55 offset:9216
    s_waitcnt vmcnt(4) lgkmcnt(14)
    s_barrier
    ds_read_b128 v[128:131], v1 offset:0
    ds_read_b128 v[136:139], v2 offset:0
    ds_read_b128 v[132:135], v1 offset:1024
    ds_read_b128 v[140:143], v2 offset:1024
    ds_read_b64_tr_b16 a[48:49], v52 offset:12288
    ds_read_b64_tr_b16 a[50:51], v52 offset:13312
    ds_read_b64_tr_b16 a[52:53], v53 offset:12288
    ds_read_b64_tr_b16 a[54:55], v53 offset:13312
    ds_read_b64_tr_b16 a[56:57], v54 offset:12288
    ds_read_b64_tr_b16 a[58:59], v54 offset:13312
    ds_read_b64_tr_b16 a[60:61], v55 offset:12288
    ds_read_b64_tr_b16 a[62:63], v55 offset:13312
    ds_read_b64_tr_b16 a[64:65], v52 offset:16384
    ds_read_b64_tr_b16 a[66:67], v52 offset:17408
    ds_read_b64_tr_b16 a[68:69], v53 offset:16384
    ds_read_b64_tr_b16 a[70:71], v53 offset:17408
    ds_read_b64_tr_b16 a[72:73], v54 offset:16384
    ds_read_b64_tr_b16 a[74:75], v54 offset:17408
    ds_read_b64_tr_b16 a[76:77], v55 offset:16384
    ds_read_b64_tr_b16 a[78:79], v55 offset:17408
    ds_read_b64_tr_b16 a[80:81], v52 offset:20480
    ds_read_b64_tr_b16 a[82:83], v52 offset:21504
    ds_read_b64_tr_b16 a[84:85], v53 offset:20480
    ds_read_b64_tr_b16 a[86:87], v53 offset:21504
    ds_read_b64_tr_b16 a[88:89], v54 offset:20480
    ds_read_b64_tr_b16 a[90:91], v54 offset:21504
    ds_read_b64_tr_b16 a[92:93], v55 offset:20480
    ds_read_b64_tr_b16 a[94:95], v55 offset:21504
    ds_read_b64_tr_b16 a[96:97], v52 offset:26624
    ds_read_b64_tr_b16 a[98:99], v52 offset:27648
    ds_read_b64_tr_b16 a[100:101], v53 offset:26624
    ds_read_b64_tr_b16 a[102:103], v53 offset:27648
    ds_read_b64_tr_b16 a[104:105], v54 offset:26624
    ds_read_b64_tr_b16 a[106:107], v54 offset:27648
    ds_read_b64_tr_b16 a[108:109], v55 offset:26624
    ds_read_b64_tr_b16 a[110:111], v55 offset:27648
    ds_read_b64_tr_b16 a[112:113], v52 offset:30720
    ds_read_b64_tr_b16 a[114:115], v52 offset:31744
    ds_read_b64_tr_b16 a[116:117], v53 offset:30720
    ds_read_b64_tr_b16 a[118:119], v53 offset:31744
    ds_read_b64_tr_b16 a[120:121], v54 offset:30720
    ds_read_b64_tr_b16 a[122:123], v54 offset:31744
    ds_read_b64_tr_b16 a[124:125], v55 offset:30720
    ds_read_b64_tr_b16 a[126:127], v55 offset:31744
    ds_read_b64_tr_b16 a[128:129], v52 offset:34816
    ds_read_b64_tr_b16 a[130:131], v52 offset:35840
    ds_read_b64_tr_b16 a[132:133], v53 offset:34816
    ds_read_b64_tr_b16 a[134:135], v53 offset:35840
    ds_read_b64_tr_b16 a[136:137], v54 offset:34816
    ds_read_b64_tr_b16 a[138:139], v54 offset:35840
    ds_read_b64_tr_b16 a[140:141], v55 offset:34816
    ds_read_b64_tr_b16 a[142:143], v55 offset:35840
    ds_read_b64_tr_b16 a[144:145], v52 offset:38912
    ds_read_b64_tr_b16 a[146:147], v52 offset:39936
    ds_read_b64_tr_b16 a[148:149], v53 offset:38912
    ds_read_b64_tr_b16 a[150:151], v53 offset:39936
    ds_read_b64_tr_b16 a[152:153], v54 offset:38912
    ds_read_b64_tr_b16 a[154:155], v54 offset:39936
    ds_read_b64_tr_b16 a[156:157], v55 offset:38912
    ds_read_b64_tr_b16 a[158:159], v55 offset:39936
    ds_read_b64_tr_b16 a[160:161], v52 offset:43008
    ds_read_b64_tr_b16 a[162:163], v52 offset:44032
    ds_read_b64_tr_b16 a[164:165], v53 offset:43008
    ds_read_b64_tr_b16 a[166:167], v53 offset:44032
    buffer_load_dwordx4 v[160:163], v40, s[20:23], s73 offen offset:0 sc1
    ds_read_b64_tr_b16 a[168:169], v54 offset:43008
    ds_read_b64_tr_b16 a[170:171], v54 offset:44032
    ds_read_b64_tr_b16 a[172:173], v55 offset:43008
    ds_read_b64_tr_b16 a[174:175], v55 offset:44032
    ds_read_b64_tr_b16 a[176:177], v52 offset:47104
    ds_read_b64_tr_b16 a[178:179], v52 offset:48128
    ds_read_b64_tr_b16 a[180:181], v53 offset:47104
    buffer_load_dwordx4 v[164:167], v40, s[20:23], s73 offen offset:1024 sc1
    ds_read_b64_tr_b16 a[182:183], v53 offset:48128
    ds_read_b64_tr_b16 a[184:185], v54 offset:47104
    ds_read_b64_tr_b16 a[186:187], v54 offset:48128
    ds_read_b64_tr_b16 a[188:189], v55 offset:47104
    ds_read_b64_tr_b16 a[190:191], v55 offset:48128
    v_add_u32 v52, 53248, v52
    v_add_u32 v53, 53248, v53
    buffer_load_dwordx4 v[168:171], v40, s[20:23], s74 offen offset:0 sc1
    v_add_u32 v54, 53248, v54
    v_add_u32 v55, 53248, v55
    ds_read_b64_tr_b16 a[192:193], v52 offset:0
    ds_read_b64_tr_b16 a[194:195], v52 offset:1024
    s_waitcnt lgkmcnt(14)
    v_mfma_f32_16x16x32_bf16 v[64:67], a[0:3], v[128:131], 0
    ds_read_b64_tr_b16 a[196:197], v53 offset:0
    ds_read_b64_tr_b16 a[198:199], v53 offset:1024
    v_mfma_f32_16x16x32_bf16 v[68:71], a[4:7], v[128:131], 0
    ds_read_b64_tr_b16 a[200:201], v54 offset:0
    buffer_load_dwordx4 v[172:175], v40, s[20:23], s74 offen offset:1024 sc1
    ds_read_b64_tr_b16 a[202:203], v54 offset:1024
    v_mfma_f32_16x16x32_bf16 v[72:75], a[8:11], v[128:131], 0
    ds_read_b64_tr_b16 a[204:205], v55 offset:0
    ds_read_b64_tr_b16 a[206:207], v55 offset:1024
    v_mfma_f32_16x16x32_bf16 v[76:79], a[12:15], v[128:131], 0
    ds_read_b64_tr_b16 a[208:209], v52 offset:4096
    ds_read_b64_tr_b16 a[210:211], v52 offset:5120
    v_mfma_f32_16x16x32_bf16 v[112:115], a[0:3], v[136:139], 0
    ds_read_b64_tr_b16 a[212:213], v53 offset:4096
    ds_read_b64_tr_b16 a[214:215], v53 offset:5120
    v_mfma_f32_16x16x32_bf16 v[64:67], a[16:19], v[132:135], v[64:67]
    buffer_load_dwordx4 v[176:179], v40, s[20:23], s75 offen offset:0 sc1
    ds_read_b64_tr_b16 a[216:217], v54 offset:4096
    ds_read_b64_tr_b16 a[218:219], v54 offset:5120
    v_mfma_f32_16x16x32_bf16 v[68:71], a[20:23], v[132:135], v[68:71]
    ds_read_b64_tr_b16 a[220:221], v55 offset:4096
    ds_read_b64_tr_b16 a[222:223], v55 offset:5120
    v_mfma_f32_16x16x32_bf16 v[72:75], a[24:27], v[132:135], v[72:75]
    ds_read_b64_tr_b16 a[224:225], v52 offset:8192
    ds_read_b64_tr_b16 a[226:227], v52 offset:9216
    v_mfma_f32_16x16x32_bf16 v[76:79], a[28:31], v[132:135], v[76:79]
    ds_read_b64_tr_b16 a[228:229], v53 offset:8192
    buffer_load_dwordx4 v[180:183], v40, s[20:23], s75 offen offset:1024 sc1
    ds_read_b64_tr_b16 a[230:231], v53 offset:9216
    v_mfma_f32_16x16x32_bf16 v[112:115], a[16:19], v[140:143], v[112:115]
    ds_read_b64_tr_b16 a[232:233], v54 offset:8192
    ds_read_b64_tr_b16 a[234:235], v54 offset:9216
    ds_read_b64_tr_b16 a[236:237], v55 offset:8192
    ds_read_b64_tr_b16 a[238:239], v55 offset:9216
    buffer_load_dwordx4 v[184:187], v40, s[20:23], s76 offen offset:0 sc1
    buffer_load_dwordx4 v[188:191], v40, s[20:23], s76 offen offset:1024 sc1
    s_waitcnt lgkmcnt(0)
L_s1:
    s_waitcnt vmcnt(7)
    v_mfma_f32_16x16x32_bf16 v[80:83], a[32:35], v[160:163], v[64:67]
    ds_read_b64_tr_b16 a[240:241], v52 offset:12288
    ds_read_b64_tr_b16 a[242:243], v52 offset:13312
    v_mfma_f32_16x16x32_bf16 v[84:87], a[36:39], v[160:163], v[68:71]
    buffer_load_dwordx4 v[144:147], v41, s[20:23], s81 offen offset:0 sc1
    ds_read_b64_tr_b16 a[244:245], v53 offset:12288
    v_mfma_f32_16x16x32_bf16 v[88:91], a[40:43], v[160:163], v[72:75]
    ds_read_b64_tr_b16 a[246:247], v53 offset:13312
    ds_read_b64_tr_b16 a[248:249], v54 offset:12288
    v_mfma_f32_16x16x32_bf16 v[92:95], a[44:47], v[160:163], v[76:79]
    ds_read_b64_tr_b16 a[250:251], v54 offset:13312
    s_waitcnt vmcnt(7)
    v_mfma_f32_16x16x32_bf16 v[80:83], a[48:51], v[164:167], v[80:83]
    ds_read_b64_tr_b16 a[252:253], v55 offset:12288
    ds_read_b64_tr_b16 a[254:255], v55 offset:13312
    v_mfma_f32_16x16x32_bf16 v[84:87], a[52:55], v[164:167], v[84:87]
    buffer_load_dwordx4 v[148:151], v41, s[20:23], s81 offen offset:1024 sc1
    ds_read_b64_tr_b16 v[224:225], v52 offset:16384
    v_mfma_f32_16x16x32_bf16 v[88:91], a[56:59], v[164:167], v[88:91]
    ds_read_b64_tr_b16 v[226:227], v52 offset:17408
    ds_read_b64_tr_b16 v[228:229], v53 offset:16384
    v_mfma_f32_16x16x32_bf16 v[92:95], a[60:63], v[164:167], v[92:95]
    ds_read_b64_tr_b16 v[230:231], v53 offset:17408
    s_waitcnt vmcnt(7)
    v_mfma_f32_16x16x32_bf16 v[80:83], a[64:67], v[168:171], v[80:83]
    v_add_u32 v120, v160, v161
    v_add3_u32 v120, v120, v162, v163
    v_mfma_f32_16x16x32_bf16 v[84:87], a[68:71], v[168:171], v[84:87]
    buffer_load_dwordx4 v[152:155], v41, s[20:23], s82 offen offset:0 sc1
    ds_read_b64_tr_b16 v[232:233], v54 offset:16384
    v_mfma_f32_16x16x32_bf16 v[88:91], a[72:75], v[168:171], v[88:91]
    ds_read_b64_tr_b16 v[234:235], v54 offset:17408
    v_add3_u32 v120, v120, v164, v165
    v_add3_u32 v120, v120, v166, v167
    v_mfma_f32_16x16x32_bf16 v[92:95], a[76:79], v[168:171], v[92:95]
    ds_read_b64_tr_b16 v[236:237], v55 offset:16384
    v_add3_u32 v120, v120, v168, v169
    v_add3_u32 v120, v120, v170, v171
    s_waitcnt vmcnt(7)
    v_mfma_f32_16x16x32_bf16 v[80:83], a[80:83], v[172:175], v[80:83]
    v_add3_u32 v120, v120, v172, v173
    v_add3_u32 v120, v120, v174, v175
    v_mfma_f32_16x16x32_bf16 v[84:87], a[84:87], v[172:175], v[84:87]
    buffer_load_dwordx4 v[156:159], v41, s[20:23], s82 offen offset:1024 sc1
    ds_read_b64_tr_b16 v[238:239], v55 offset:17408
    v_mfma_f32_16x16x32_bf16 v[88:91], a[88:91], v[172:175], v[88:91]
    ds_read_b64_tr_b16 v[240:241], v52 offset:20480
    ds_read_b64_tr_b16 v[242:243], v52 offset:21504
    v_mfma_f32_16x16x32_bf16 v[92:95], a[92:95], v[172:175], v[92:95]
    ds_read_b64_tr_b16 v[244:245], v53 offset:20480
    ds_read_b64_tr_b16 v[246:247], v53 offset:21504
    s_waitcnt vmcnt(7)
    v_mfma_f32_16x16x32_bf16 v[80:83], a[96:99], v[176:179], v[80:83]
    v_add3_u32 v120, v120, v176, v177
    v_add3_u32 v120, v120, v178, v179
    v_mfma_f32_16x16x32_bf16 v[84:87], a[100:103], v[176:179], v[84:87]
    buffer_load_dword v124, v43, s[20:23], 0 offen sc1
    ds_read_b64_tr_b16 v[248:249], v54 offset:20480
    v_mfma_f32_16x16x32_bf16 v[88:91], a[104:107], v[176:179], v[88:91]
    ds_read_b64_tr_b16 v[250:251], v54 offset:21504
    ds_read_b64_tr_b16 v[252:253], v55 offset:20480
    v_mfma_f32_16x16x32_bf16 v[92:95], a[108:111], v[176:179], v[92:95]
    ds_read_b64_tr_b16 v[254:255], v55 offset:21504
    s_waitcnt vmcnt(7)
    v_mfma_f32_16x16x32_bf16 v[80:83], a[112:115], v[180:183], v[80:83]
    v_add3_u32 v120, v120, v180, v181
    v_add3_u32 v120, v120, v182, v183
    v_mfma_f32_16x16x32_bf16 v[84:87], a[116:119], v[180:183], v[84:87]
    buffer_load_dwordx4 v[192:195], v40, s[20:23], s77 offen offset:0 sc1
    v_mfma_f32_16x16x32_bf16 v[88:91], a[120:123], v[180:183], v[88:91]
    v_mfma_f32_16x16x32_bf16 v[92:95], a[124:127], v[180:183], v[92:95]
    s_waitcnt vmcnt(7)
    v_mfma_f32_16x16x32_bf16 v[80:83], a[128:131], v[184:187], v[80:83]
    v_add3_u32 v120, v120, v184, v185
    v_add3_u32 v120, v120, v186, v187
    v_mfma_f32_16x16x32_bf16 v[84:87], a[132:135], v[184:187], v[84:87]
    buffer_load_dwordx4 v[196:199], v40, s[20:23], s77 offen offset:1024 sc1
    v_mfma_f32_16x16x32_bf16 v[88:91], a[136:139], v[184:187], v[88:91]
    v_mfma_f32_16x16x32_bf16 v[92:95], a[140:143], v[184:187], v[92:95]
    s_waitcnt vmcnt(7)
    v_mfma_f32_16x16x32_bf16 v[80:83], a[144:147], v[188:191], v[80:83]
    v_add3_u32 v120, v120, v188, v189
    v_add3_u32 v120, v120, v190, v191
    v_mfma_f32_16x16x32_bf16 v[84:87], a[148:151], v[188:191], v[84:87]
    buffer_load_dwordx4 v[200:203], v40, s[20:23], s78 offen offset:0 sc1
    v_mfma_f32_16x16x32_bf16 v[88:91], a[152:155], v[188:191], v[88:91]
    v_mfma_f32_16x16x32_bf16 v[92:95], a[156:159], v[188:191], v[92:95]
    s_bitcmp1_b32 s40, 1
    s_waitcnt lgkmcnt(0)
    s_cbranch_scc1 L_x2
    s_bitcmp1_b32 s40, 0
    s_cbranch_scc1 L_x1
    s_waitcnt vmcnt(7)
    v_mfma_f32_16x16x32_bf16 v[96:99], a[32:35], v[144:147], v[112:115]
    v_add3_u32 v120, v120, v144, v145
    v_add3_u32 v120, v120, v146, v147
    v_mfma_f32_16x16x32_bf16 v[100:103], a[36:39], v[144:147], 0
    buffer_load_dwordx4 v[204:207], v40, s[20:23], s78 offen offset:1024 sc1
    v_mfma_f32_16x16x32_bf16 v[104:107], a[40:43], v[144:147], 0
    v_mfma_f32_16x16x32_bf16 v[108:111], a[44:47], v[144:147], 0
    s_waitcnt vmcnt(7)
    v_mfma_f32_16x16x32_bf16 v[96:99], a[48:51], v[148:151], v[96:99]
    v_add3_u32 v120, v120, v148, v149
    v_add3_u32 v120, v120, v150, v151
    v_mfma_f32_16x16x32_bf16 v[100:103], a[52:55], v[148:151], v[100:103]
    buffer_load_dwordx4 v[208:211], v40, s[20:23], s79 offen offset:0 sc1
    v_mfma_f32_16x16x32_bf16 v[104:107], a[56:59], v[148:151], v[104:107]
    s_waitcnt vmcnt(7)
    v_add3_u32 v120, v120, v152, v153
    v_add3_u32 v120, v120, v154, v155
    v_mfma_f32_16x16x32_bf16 v[108:111], a[60:63], v[148:151], v[108:111]
    s_waitcnt vmcnt(6)
    v_add3_u32 v120, v120, v156, v157
    v_add3_u32 v120, v120, v158, v159
    v_mfma_f32_16x16x32_bf16 v[96:99], a[64:67], v[152:155], v[96:99]
    s_waitcnt vmcnt(5)
    v_xor_b32 v124, v124, v3
    v_sub_u32 v120, v120, v124
    v_mfma_f32_16x16x32_bf16 v[100:103], a[68:71], v[152:155], v[100:103]
    buffer_load_dwordx4 v[212:215], v40, s[20:23], s79 offen offset:1024 sc1
    v_mfma_f32_16x16x32_bf16 v[104:107], a[72:75], v[152:155], v[104:107]
    s_nop 0
    v_add_u32_dpp v120, v120, v120 row_ror:8 row_mask:0xf bank_mask:0xf
    v_mfma_f32_16x16x32_bf16 v[108:111], a[76:79], v[152:155], v[108:111]
    s_nop 0
    v_add_u32_dpp v120, v120, v120 row_ror:4 row_mask:0xf bank_mask:0xf
    v_mfma_f32_16x16x32_bf16 v[96:99], a[80:83], v[156:159], v[96:99]
    s_nop 0
    v_add_u32_dpp v120, v120, v120 row_ror:2 row_mask:0xf bank_mask:0xf
    v_mfma_f32_16x16x32_bf16 v[100:103], a[84:87], v[156:159], v[100:103]
    buffer_load_dword v125, v5, s[20:23], 0 offen sc1
    s_nop 0
    v_add_u32_dpp v120, v120, v120 row_ror:1 row_mask:0xf bank_mask:0xf
    v_mfma_f32_16x16x32_bf16 v[104:107], a[88:91], v[156:159], v[104:107]
    v_cmp_ne_u32 vcc, 0, v120
    v_mfma_f32_16x16x32_bf16 v[108:111], a[92:95], v[156:159], v[108:111]
    s_branch L_xdone
L_x1:
    s_waitcnt vmcnt(7)
    v_mfma_f32_16x16x32_bf16 v[96:99], a[96:99], v[144:147], v[112:115]
    v_add3_u32 v120, v120, v144, v145
    v_add3_u32 v120, v120, v146, v147
    v_mfma_f32_16x16x32_bf16 v[100:103], a[100:103], v[144:147], 0
    buffer_load_dwordx4 v[204:207], v40, s[20:23], s78 offen offset:1024 sc1
    v_mfma_f32_16x16x32_bf16 v[104:107], a[104:107], v[144:147], 0
    v_mfma_f32_16x16x32_bf16 v[108:111], a[108:111], v[144:147], 0
    s_waitcnt vmcnt(7)
    v_mfma_f32_16x16x32_bf16 v[96:99], a[112:115], v[148:151], v[96:99]
    v_add3_u32 v120, v120, v148, v149
    v_add3_u32 v120, v120, v150, v151
    v_mfma_f32_16x16x32_bf16 v[100:103], a[116:119], v[148:151], v[100:103]
    buffer_load_dwordx4 v[208:211], v40, s[20:23], s79 offen offset:0 sc1
    v_mfma_f32_16x16x32_bf16 v[104:107], a[120:123], v[148:151], v[104:107]
    s_waitcnt vmcnt(7)
    v_add3_u32 v120, v120, v152, v153
    v_add3_u32 v120, v120, v154, v155
    v_mfma_f32_16x16x32_bf16 v[108:111], a[124:127], v[148:151], v[108:111]
    s_waitcnt vmcnt(6)
    v_add3_u32 v120, v120, v156, v157
    v_add3_u32 v120, v120, v158, v159
    v_mfma_f32_16x16x32_bf16 v[96:99], a[128:131], v[152:155], v[96:99]
    s_waitcnt vmcnt(5)
    v_xor_b32 v124, v124, v3
    v_sub_u32 v120, v120, v124
    v_mfma_f32_16x16x32_bf16 v[100:103], a[132:135], v[152:155], v[100:103]
    buffer_load_dwordx4 v[212:215], v40, s[20:23], s79 offen offset:1024 sc1
    v_mfma_f32_16x16x32_bf16 v[104:107], a[136:139], v[152:155], v[104:107]
    s_nop 0
    v_add_u32_dpp v120, v120, v120 row_ror:8 row_mask:0xf bank_mask:0xf
    v_mfma_f32_16x16x32_bf16 v[108:111], a[140:143], v[152:155], v[108:111]
    s_nop 0
    v_add_u32_dpp v120, v120, v120 row_ror:4 row_mask:0xf bank_mask:0xf
    v_mfma_f32_16x16x32_bf16 v[96:99], a[144:147], v[156:159], v[96:99]
    s_nop 0
    v_add_u32_dpp v120, v120, v120 row_ror:2 row_mask:0xf bank_mask:0xf
    v_mfma_f32_16x16x32_bf16 v[100:103], a[148:151], v[156:159], v[100:103]
    buffer_load_dword v125, v5, s[20:23], 0 offen sc1
    s_nop 0
    v_add_u32_dpp v120, v120, v120 row_ror:1 row_mask:0xf bank_mask:0xf
    v_mfma_f32_16x16x32_bf16 v[104:107], a[152:155], v[156:159], v[104:107]
    v_cmp_ne_u32 vcc, 0, v120
    v_mfma_f32_16x16x32_bf16 v[108:111], a[156:159], v[156:159], v[108:111]
    s_branch L_xdone
L_x2:
    s_bitcmp1_b32 s40, 0
    s_cbranch_scc1 L_x3
    s_waitcnt vmcnt(7)
    v_mfma_f32_16x16x32_bf16 v[96:99], a[160:163], v[144:147], v[112:115]
    v_add3_u32 v120, v120, v144, v145
    v_add3_u32 v120, v120, v146, v147
    v_mfma_f32_16x16x32_bf16 v[100:103], a[164:167], v[144:147], 0
    buffer_load_dwordx4 v[204:207], v40, s[20:23], s78 offen offset:1024 sc1
    v_mfma_f32_16x16x32_bf16 v[104:107], a[168:171], v[144:147], 0
    v_mfma_f32_16x16x32_bf16 v[108:111], a[172:175], v[144:147], 0
    s_waitcnt vmcnt(7)
    v_mfma_f32_16x16x32_bf16 v[96:99], a[176:179], v[148:151], v[96:99]
    v_add3_u32 v120, v120, v148, v149
    v_add3_u32 v120, v120, v150, v151
    v_mfma_f32_16x16x32_bf16 v[100:103], a[180:183], v[148:151], v[100:103]
    buffer_load_dwordx4 v[208:211], v40, s[20:23], s79 offen offset:0 sc1
    v_mfma_f32_16x16x32_bf16 v[104:107], a[184:187], v[148:151], v[104:107]
    s_waitcnt vmcnt(7)
    v_add3_u32 v120, v120, v152, v153
    v_add3_u32 v120, v120, v154, v155
    v_mfma_f32_16x16x32_bf16 v[108:111], a[188:191], v[148:151], v[108:111]
    s_waitcnt vmcnt(6)
    v_add3_u32 v120, v120, v156, v157
    v_add3_u32 v120, v120, v158, v159
    v_mfma_f32_16x16x32_bf16 v[96:99], a[192:195], v[152:155], v[96:99]
    s_waitcnt vmcnt(5)
    v_xor_b32 v124, v124, v3
    v_sub_u32 v120, v120, v124
    v_mfma_f32_16x16x32_bf16 v[100:103], a[196:199], v[152:155], v[100:103]
    buffer_load_dwordx4 v[212:215], v40, s[20:23], s79 offen offset:1024 sc1
    v_mfma_f32_16x16x32_bf16 v[104:107], a[200:203], v[152:155], v[104:107]
    s_nop 0
    v_add_u32_dpp v120, v120, v120 row_ror:8 row_mask:0xf bank_mask:0xf
    v_mfma_f32_16x16x32_bf16 v[108:111], a[204:207], v[152:155], v[108:111]
    s_nop 0
    v_add_u32_dpp v120, v120, v120 row_ror:4 row_mask:0xf bank_mask:0xf
    v_mfma_f32_16x16x32_bf16 v[96:99], a[208:211], v[156:159], v[96:99]
    s_nop 0
    v_add_u32_dpp v120, v120, v120 row_ror:2 row_mask:0xf bank_mask:0xf
    v_mfma_f32_16x16x32_bf16 v[100:103], a[212:215], v[156:159], v[100:103]
    buffer_load_dword v125, v5, s[20:23], 0 offen sc1
    s_nop 0
    v_add_u32_dpp v120, v120, v120 row_ror:1 row_mask:0xf bank_mask:0xf
    v_mfma_f32_16x16x32_bf16 v[104:107], a[216:219], v[156:159], v[104:107]
    v_cmp_ne_u32 vcc, 0, v120
    v_mfma_f32_16x16x32_bf16 v[108:111], a[220:223], v[156:159], v[108:111]
    s_branch L_xdone
L_x3:
    s_waitcnt vmcnt(7)
    v_mfma_f32_16x16x32_bf16 v[96:99], a[224:227], v[144:147], v[112:115]
    v_add3_u32 v120, v120, v144, v145
    v_add3_u32 v120, v120, v146, v147
    v_mfma_f32_16x16x32_bf16 v[100:103], a[228:231], v[144:147], 0
    buffer_load_dwordx4 v[204:207], v40, s[20:23], s78 offen offset:1024 sc1
    v_mfma_f32_16x16x32_bf16 v[104:107], a[232:235], v[144:147], 0
    v_mfma_f32_16x16x32_bf16 v[108:111], a[236:239], v[144:147], 0
    s_waitcnt vmcnt(7)
    v_mfma_f32_16x16x32_bf16 v[96:99], a[240:243], v[148:151], v[96:99]
    v_add3_u32 v120, v120, v148, v149
    v_add3_u32 v120, v120, v150, v151
    v_mfma_f32_16x16x32_bf16 v[100:103], a[244:247], v[148:151], v[100:103]
    buffer_load_dwordx4 v[208:211], v40, s[20:23], s79 offen offset:0 sc1
    v_mfma_f32_16x16x32_bf16 v[104:107], a[248:251], v[148:151], v[104:107]
    s_waitcnt vmcnt(7)
    v_add3_u32 v120, v120, v152, v153
    v_add3_u32 v120, v120, v154, v155
    v_mfma_f32_16x16x32_bf16 v[108:111], a[252:255], v[148:151], v[108:111]
    s_waitcnt vmcnt(6)
    v_add3_u32 v120, v120, v156, v157
    v_add3_u32 v120, v120, v158, v159
    v_mfma_f32_16x16x32_bf16 v[96:99], v[224:227], v[152:155], v[96:99]
    s_waitcnt vmcnt(5)
    v_xor_b32 v124, v124, v3
    v_sub_u32 v120, v120, v124
    v_mfma_f32_16x16x32_bf16 v[100:103], v[228:231], v[152:155], v[100:103]
    buffer_load_dwordx4 v[212:215], v40, s[20:23], s79 offen offset:1024 sc1
    v_mfma_f32_16x16x32_bf16 v[104:107], v[232:235], v[152:155], v[104:107]
    s_nop 0
    v_add_u32_dpp v120, v120, v120 row_ror:8 row_mask:0xf bank_mask:0xf
    v_mfma_f32_16x16x32_bf16 v[108:111], v[236:239], v[152:155], v[108:111]
    s_nop 0
    v_add_u32_dpp v120, v120, v120 row_ror:4 row_mask:0xf bank_mask:0xf
    v_mfma_f32_16x16x32_bf16 v[96:99], v[240:243], v[156:159], v[96:99]
    s_nop 0
    v_add_u32_dpp v120, v120, v120 row_ror:2 row_mask:0xf bank_mask:0xf
    v_mfma_f32_16x16x32_bf16 v[100:103], v[244:247], v[156:159], v[100:103]
    buffer_load_dword v125, v5, s[20:23], 0 offen sc1
    s_nop 0
    v_add_u32_dpp v120, v120, v120 row_ror:1 row_mask:0xf bank_mask:0xf
    v_mfma_f32_16x16x32_bf16 v[104:107], v[248:251], v[156:159], v[104:107]
    v_cmp_ne_u32 vcc, 0, v120
    v_mfma_f32_16x16x32_bf16 v[108:111], v[252:255], v[156:159], v[108:111]
L_xdone:
    s_cbranch_vccnz L_redo1
L_s2:
    s_waitcnt vmcnt(6)
    v_mfma_f32_16x16x32_bf16 v[64:67], a[160:163], v[192:195], v[80:83]
    v_add_u32 v120, v192, v193
    v_add3_u32 v120, v120, v194, v195
    v_mfma_f32_16x16x32_bf16 v[68:71], a[164:167], v[192:195], v[84:87]
    buffer_load_dwordx4 v[216:219], v40, s[20:23], s80 offen offset:0 sc1
    ds_write_b64 v20, v[96:97] offset:0
    v_mfma_f32_16x16x32_bf16 v[72:75], a[168:171], v[192:195], v[88:91]
    v_mfma_f32_16x16x32_bf16 v[76:79], a[172:175], v[192:195], v[92:95]
    ds_write_b64 v20, v[98:99] offset:8
    s_waitcnt vmcnt(6)
    v_mfma_f32_16x16x32_bf16 v[64:67], a[176:179], v[196:199], v[64:67]
    v_add3_u32 v120, v120, v196, v197
    v_add3_u32 v120, v120, v198, v199
    v_mfma_f32_16x16x32_bf16 v[68:71], a[180:183], v[196:199], v[68:71]
    buffer_load_dwordx4 v[220:223], v40, s[20:23], s80 offen offset:1024 sc1
    ds_write_b64 v21, v[100:101] offset:0
    v_mfma_f32_16x16x32_bf16 v[72:75], a[184:187], v[196:199], v[72:75]
    ds_write_b64 v21, v[102:103] offset:8
    v_mfma_f32_16x16x32_bf16 v[76:79], a[188:191], v[196:199], v[76:79]
    ds_write_b64 v22, v[104:105] offset:0
    s_waitcnt vmcnt(6)
    v_mfma_f32_16x16x32_bf16 v[64:67], a[192:195], v[200:203], v[64:67]
    v_add3_u32 v120, v120, v200, v201
    v_add3_u32 v120, v120, v202, v203
    v_mfma_f32_16x16x32_bf16 v[68:71], a[196:199], v[200:203], v[68:71]
    ds_write_b64 v22, v[106:107] offset:8
    v_mfma_f32_16x16x32_bf16 v[72:75], a[200:203], v[200:203], v[72:75]
    ds_write_b64 v23, v[108:109] offset:0
    v_mfma_f32_16x16x32_bf16 v[76:79], a[204:207], v[200:203], v[76:79]
    ds_write_b64 v23, v[110:111] offset:8
    s_waitcnt vmcnt(5)
    v_mfma_f32_16x16x32_bf16 v[64:67], a[208:211], v[204:207], v[64:67]
    v_add3_u32 v120, v120, v204, v205
    v_add3_u32 v120, v120, v206, v207
    v_mfma_f32_16x16x32_bf16 v[68:71], a[212:215], v[204:207], v[68:71]
    v_mfma_f32_16x16x32_bf16 v[72:75], a[216:219], v[204:207], v[72:75]
    s_cmp_lg_u32 s3, 0
    v_mfma_f32_16x16x32_bf16 v[76:79], a[220:223], v[204:207], v[76:79]
    s_waitcnt lgkmcnt(0)
    s_cbranch_scc1 L_nobar
    s_barrier
L_nobar:
    s_waitcnt vmcnt(4)
    v_mfma_f32_16x16x32_bf16 v[64:67], a[224:227], v[208:211], v[64:67]
    ds_read_b128 v[144:147], v24 offset:0
    v_add3_u32 v120, v120, v208, v209
    v_add3_u32 v120, v120, v210, v211
    v_mfma_f32_16x16x32_bf16 v[68:71], a[228:231], v[208:211], v[68:71]
    ds_read_b128 v[148:151], v24 offset:4096
    v_mfma_f32_16x16x32_bf16 v[72:75], a[232:235], v[208:211], v[72:75]
    ds_read_b128 v[152:155], v24 offset:8192
    v_mfma_f32_16x16x32_bf16 v[76:79], a[236:239], v[208:211], v[76:79]
    ds_read_b128 v[156:159], v24 offset:12288
    s_waitcnt vmcnt(3)
    v_mfma_f32_16x16x32_bf16 v[64:67], a[240:243], v[212:215], v[64:67]
    v_add3_u32 v120, v120, v212, v213
    v_add3_u32 v120, v120, v214, v215
    v_mfma_f32_16x16x32_bf16 v[68:71], a[244:247], v[212:215], v[68:71]
    s_waitcnt vmcnt(2)
    v_xor_b32 v125, v125, v4
    v_sub_u32 v120, v120, v125
    v_mfma_f32_16x16x32_bf16 v[72:75], a[248:251], v[212:215], v[72:75]
    s_waitcnt lgkmcnt(0)
    v_add_f32 v144, v144, v148
    v_add_f32 v145, v145, v149
    v_mfma_f32_16x16x32_bf16 v[76:79], a[252:255], v[212:215], v[76:79]
    v_add_f32 v146, v146, v150
    v_add_f32 v147, v147, v151
    s_waitcnt vmcnt(1)
    v_mfma_f32_16x16x32_bf16 v[64:67], v[224:227], v[216:219], v[64:67]
    v_add3_u32 v120, v120, v216, v217
    v_add3_u32 v120, v120, v218, v219
    v_mfma_f32_16x16x32_bf16 v[68:71], v[228:231], v[216:219], v[68:71]
    s_waitcnt vmcnt(0)
    v_add3_u32 v120, v120, v220, v221
    v_add3_u32 v120, v120, v222, v223
    v_mfma_f32_16x16x32_bf16 v[64:67], v[240:243], v[220:223], v[64:67]
    v_add_f32 v144, v144, v152
    v_add_u32_dpp v120, v120, v120 row_ror:8 row_mask:0xf bank_mask:0xf
    v_mfma_f32_16x16x32_bf16 v[68:71], v[244:247], v[220:223], v[68:71]
    v_add_f32 v145, v145, v153
    v_add_u32_dpp v120, v120, v120 row_ror:4 row_mask:0xf bank_mask:0xf
    v_mfma_f32_16x16x32_bf16 v[72:75], v[232:235], v[216:219], v[72:75]
    v_add_f32 v146, v146, v154
    v_add_u32_dpp v120, v120, v120 row_ror:2 row_mask:0xf bank_mask:0xf
    v_mfma_f32_16x16x32_bf16 v[72:75], v[248:251], v[220:223], v[72:75]
    v_add_f32 v147, v147, v155
    v_add_u32_dpp v120, v120, v120 row_ror:1 row_mask:0xf bank_mask:0xf
    v_mfma_f32_16x16x32_bf16 v[76:79], v[236:239], v[216:219], v[76:79]
    v_cmp_ne_u32 vcc, 0, v120
    v_cvt_pk_bf16_f32 v6, v64, v65
    v_cvt_pk_bf16_f32 v7, v66, v67
    v_cvt_pk_bf16_f32 v8, v68, v69
    v_cvt_pk_bf16_f32 v9, v70, v71
    v_mfma_f32_16x16x32_bf16 v[76:79], v[252:255], v[220:223], v[76:79]
    ds_write_b64 v16, v[6:7]
    ds_write_b64 v17, v[8:9]
    v_add_f32 v144, v144, v156
    v_add_f32 v145, v145, v157
    v_add_f32 v146, v146, v158
    v_cvt_pk_bf16_f32 v10, v72, v73
    v_cvt_pk_bf16_f32 v11, v74, v75
    s_nop 0
    v_cvt_pk_bf16_f32 v12, v76, v77
    v_cvt_pk_bf16_f32 v13, v78, v79
    ds_write_b64 v18, v[10:11]
    ds_write_b64 v19, v[12:13]
    ds_read_b128 v[128:131], v59 offset:0
    ds_read_b128 v[132:135], v59 offset:1024
    v_add_f32 v147, v147, v159
    v_cvt_pk_bf16_f32 v148, v144, v145
    v_cvt_pk_bf16_f32 v149, v146, v147
    buffer_store_dwordx2 v[148:149], v58, s[16:19], 0 offen sc1
    s_cbranch_vccnz L_redo2
L_s3:
    s_waitcnt lgkmcnt(1)
    buffer_store_dwordx4 v[128:131], v56, s[16:19], 0 offen sc1
    s_waitcnt lgkmcnt(0)
    buffer_store_dwordx4 v[132:135], v57, s[16:19], 0 offen sc1
L_end:
    s_endpgm
L_redo1:
    s_cmp_eq_u32 s59, 0
    s_cbranch_scc1 L_s2
    s_sub_u32 s59, s59, 1
    s_waitcnt vmcnt(0)
    buffer_load_dwordx4 v[160:163], v40, s[20:23], s73 offen offset:0 sc1
    buffer_load_dwordx4 v[164:167], v40, s[20:23], s73 offen offset:1024 sc1
    buffer_load_dwordx4 v[168:171], v40, s[20:23], s74 offen offset:0 sc1
    buffer_load_dwordx4 v[172:175], v40, s[20:23], s74 offen offset:1024 sc1
    buffer_load_dwordx4 v[176:179], v40, s[20:23], s75 offen offset:0 sc1
    buffer_load_dwordx4 v[180:183], v40, s[20:23], s75 offen offset:1024 sc1
    buffer_load_dwordx4 v[184:187], v40, s[20:23], s76 offen offset:0 sc1
    buffer_load_dwordx4 v[188:191], v40, s[20:23], s76 offen offset:1024 sc1
    s_branch L_s1
L_redo2:
    s_cmp_eq_u32 s59, 0
    s_cbranch_scc1 L_s3
    s_sub_u32 s59, s59, 1
    s_mov_b32 s3, 1
    s_waitcnt vmcnt(0) lgkmcnt(0)
    buffer_load_dwordx4 v[192:195], v40, s[20:23], s77 offen offset:0 sc1
    buffer_load_dwordx4 v[196:199], v40, s[20:23], s77 offen offset:1024 sc1
    buffer_load_dwordx4 v[200:203], v40, s[20:23], s78 offen offset:0 sc1
    buffer_load_dwordx4 v[204:207], v40, s[20:23], s78 offen offset:1024 sc1
    buffer_load_dwordx4 v[208:211], v40, s[20:23], s79 offen offset:0 sc1
    buffer_load_dwordx4 v[212:215], v40, s[20:23], s79 offen offset:1024 sc1
    buffer_load_dword v125, v5, s[20:23], 0 offen sc1
    s_branch L_s2
L_code_end:
.section .rodata,"a"
.p2align 6
.amdhsa_kernel standalone__sliding_local_dilated__prompt_kernel
  .amdhsa_next_free_vgpr 512
  .amdhsa_next_free_sgpr 102
  .amdhsa_accum_offset 256
  .amdhsa_group_segment_fixed_size 0
  .amdhsa_kernarg_size 48
  .amdhsa_user_sgpr_count 2
  .amdhsa_user_sgpr_kernarg_segment_ptr 1
  .amdhsa_system_sgpr_workgroup_id_x 1
.end_amdhsa_kernel
```
